```python
import torch

def _softmax(x, axis=-1):
    return torch.softmax(x, dim=axis)
def _gelu(x):
    return torch.nn.functional.gelu(x, approximate="tanh")
def _silu(x):
    return torch.nn.functional.silu(x)
def _sigmoid(x):
    return torch.sigmoid(x)
def _layernorm(x, axis=-1, eps=1e-5):
    m = x.mean(dim=axis, keepdim=True)
    v = x.var(dim=axis, keepdim=True, unbiased=False)
    return (x - m) / torch.sqrt(v + eps)
def _scatter_add(tgt, idx, src, axis=0):
    return tgt.clone().index_add_(axis, idx, src)
def _segment_sum(src, seg, n):
    out = torch.zeros((n,) + src.shape[1:], dtype=src.dtype)
    return out.index_add_(0, seg, src)
def _pad(x, pw):
    flat = tuple(v for pair in reversed(pw) for v in pair)
    return torch.nn.functional.pad(x, flat)

kernel_name = 'recurrent_scan__ssm_conv_s5__swiglu_ffn__prompt'

def setup_inputs():

    _w = (lambda a: (lambda t: t.to(torch.bfloat16) if t.is_floating_point() else t)(torch.as_tensor(a)))
    def _A_setup():
        B, S, D = 1, 2048, 512
        P = D
        Lambda_re = -0.5 * (lambda _x: torch.exp(torch.as_tensor(_x)))((lambda *s: torch.randn(*s, dtype=torch.bfloat16) * 0.2)(P))
        Lambda_im = (lambda *s: torch.randn(*s, dtype=torch.bfloat16) * 0.4)(P) * 1.0
        B_re = (lambda *s: torch.randn(*s, dtype=torch.bfloat16) * 0.2)(P, D) * (D ** -0.5)
        B_im = (lambda *s: torch.randn(*s, dtype=torch.bfloat16) * 0.2)(P, D) * (D ** -0.5)
        C_re = (lambda *s: torch.randn(*s, dtype=torch.bfloat16) * 0.2)(D, P) * (P ** -0.5)
        C_im = (lambda *s: torch.randn(*s, dtype=torch.bfloat16) * 0.2)(D, P) * (P ** -0.5)
        log_dt = (lambda *s: torch.randn(*s, dtype=torch.bfloat16) * 0.2)(P) * 0.3 - 2.0
        Dskip = (lambda *s: torch.randn(*s, dtype=torch.bfloat16) * 0.05)(D)
        return {
            "x": _w((lambda *s: torch.randn(*s, dtype=torch.bfloat16) * 0.05)(B, S, D)),
            "Lambda_re": _w(Lambda_re),
            "Lambda_im": _w(Lambda_im),
            "B_re": _w(B_re),
            "B_im": _w(B_im),
            "C_re": _w(C_re),
            "C_im": _w(C_im),
            "log_dt": _w(log_dt),
            "Dskip": _w(Dskip),
        }
    _A_in = _A_setup()

    def _B_setup():
        B, S, D, F = 1, 2048, 512, 1792
        return {
            "x": _w((lambda *s: torch.randn(*s, dtype=torch.bfloat16) * 0.05)(B, S, D)),
            "w_gate": _w((lambda *s: torch.randn(*s, dtype=torch.bfloat16) * 0.05)(D, F)),
            "w_up": _w((lambda *s: torch.randn(*s, dtype=torch.bfloat16) * 0.05)(D, F)),
            "w_down": _w((lambda *s: torch.randn(*s, dtype=torch.bfloat16) * 0.05)(F, D)),
        }
    _B_in = _B_setup()

    return {
        "A_x": _A_in["x"],
        "A_Lambda_re": _A_in["Lambda_re"],
        "A_Lambda_im": _A_in["Lambda_im"],
        "A_B_re": _A_in["B_re"],
        "A_B_im": _A_in["B_im"],
        "A_C_re": _A_in["C_re"],
        "A_C_im": _A_in["C_im"],
        "A_log_dt": _A_in["log_dt"],
        "A_Dskip": _A_in["Dskip"],
        "B_x": _B_in["x"],
        "B_w_gate": _B_in["w_gate"],
        "B_w_up": _B_in["w_up"],
        "B_w_down": _B_in["w_down"],
    }

def reference(A_x, A_Lambda_re, A_Lambda_im, A_B_re, A_B_im, A_C_re, A_C_im, A_log_dt, A_Dskip, B_x, B_w_gate, B_w_up, B_w_down):
    def _A_ref(x, Lambda_re, Lambda_im, B_re, B_im, C_re, C_im, log_dt, Dskip):
        Bsz, L, H = x.shape
        Lam = Lambda_re + 1j * Lambda_im
        Bmat = B_re + 1j * B_im
        Cmat = C_re + 1j * C_im
        dt = torch.exp(log_dt)
        Lam_bar = torch.exp(dt * Lam)
        B_bar = ((Lam_bar - 1.0) / Lam)[:, None] * Bmat
        Bu = torch.einsum("bld,pd->blp", x + 0j, B_bar)
        h = torch.zeros_like(Bu[:, 0, :])
        hs = []
        for t in range(L):
            h = Lam_bar[None, :] * h + Bu[:, t, :]
            hs.append(h)
        hseq = torch.stack(hs, 1)
        y = 2.0 * torch.einsum("blp,dp->bld", hseq, Cmat).real + x * Dskip[None, None, :]
        return y

    def _B_ref(x, w_gate, w_up, w_down):
        g = _silu(x @ w_gate)
        u = x @ w_up
        return (g * u) @ w_down

    x = A_x
    xn = _layernorm(x, axis=-1)
    s = _A_ref(xn, A_Lambda_re, A_Lambda_im, A_B_re, A_B_im, A_C_re, A_C_im, A_log_dt, A_Dskip)
    g = _silu(_B_ref(xn, B_w_gate, B_w_up, B_w_down))
    return x + s * g
```

```asm
; @launch grid=(256,1,1) block=(256,1,1) lds=163840
.amdgcn_target "amdgcn-amd-amdhsa--gfx950"
.text
.globl recurrent_scan__ssm_conv_s5__swiglu_ffn__prompt_kernel
.p2align 8
.type recurrent_scan__ssm_conv_s5__swiglu_ffn__prompt_kernel,@function
recurrent_scan__ssm_conv_s5__swiglu_ffn__prompt_kernel:
  s_cmp_ge_u32 s2, 0x100
  s_cbranch_scc1 K1_DONE
  s_load_dwordx16 s[52:67], s[0:1], 0
  s_load_dwordx16 s[68:83], s[0:1], 64
  s_getpc_b64 s[4:5]
  s_lshr_b32 s3, s2, 3
  s_lshl_b32 s3, s3, 10
  v_and_b32_e64 v2, 63, v0
  v_lshl_add_u32 v2, v2, 4, s3
  v_min_u32 v2, 0x6ff0, v2
  global_load_dwordx4 a[192:195], v2, s[4:5]
  v_and_b32 v1, 63, v0
  v_lshrrev_b32 v2, 6, v0
  s_nop 0
  v_readfirstlane_b32 s32, v2
  s_and_b32 s45, s2, 7
  s_lshr_b32 s46, s2, 3
  s_and_b32 s47, s45, 1
  s_lshl_b32 s47, s47, 3
  s_and_b32 s48, s46, 7
  s_add_u32 s33, s47, s48
  s_lshr_b32 s47, s45, 1
  s_lshl_b32 s47, s47, 2
  s_lshr_b32 s46, s46, 3
  s_add_u32 s34, s47, s46
  s_lshr_b32 s46, s2, 1
  s_and_b32 s46, s46, 3
  s_lshl_b32 s46, s46, 1
  s_add_u32 s35, s48, s46
  s_and_b32 s35, s35, 7
  v_and_b32 v184, 7, v1
  v_lshrrev_b32 v185, 3, v1
  v_lshrrev_b32 v186, 1, v185
  v_xor_b32 v186, v186, v184
  v_lshlrev_b32 v186, 4, v186
  v_xor_b32_e64 v187, 64, v186
  v_bfe_u32 v188, v185, 2, 1
  v_lshlrev_b32 v188, 4, v188
  v_and_b32 v189, 3, v185
  v_add_u32 v188, v188, v189
  v_lshlrev_b32 v188, 10, v188
  v_add_u32 v176, v188, v186
  v_add_u32 v177, v188, v187
  v_add_u32 v177, 0xc00, v177
  v_add_u32_e64 v178, v188, v186
  v_add_u32 v178, 0x1800, v178
  v_add_u32_e64 v179, v188, v187
  v_add_u32 v179, 0x2400, v179
  v_lshlrev_b32 v188, 10, v185
  v_add_u32 v180, v188, v186
  v_add_u32 v181, v188, v187
  v_add_u32 v181, 0x1c00, v181
  s_lshl_b32 s45, s33, 7
  s_lshl_b32 s46, s32, 5
  s_add_u32 s45, s45, s46
  s_lshl_b32 s36, s45, 10
  s_and_b32 s47, s32, 1
  s_lshr_b32 s48, s32, 1
  s_lshl_b32 s45, s34, 5
  s_lshl_b32 s46, s47, 4
  s_add_u32 s45, s45, s46
  s_lshl_b32 s37, s45, 10
  s_mul_i32 s45, s47, 114688
  s_mul_i32 s46, s34, 224
  s_add_u32 s38, s45, s46
  s_lshl_b32 s39, s32, 12
  s_lshl_b32 s45, s48, 12
  s_lshl_b32 s46, s47, 11
  s_add_u32 s45, s45, s46
  s_add_u32 s40, s45, 16384
  s_mul_i32 s45, s48, 14464
  s_mul_i32 s46, s47, 7168
  s_add_u32 s41, s45, s46
  v_and_b32 v13, 31, v1
  s_lshl_b32 s45, s34, 5
  v_add_u32 v185, s45, v13
  v_lshlrev_b32 v185, 1, v185
  v_mov_b32 v184, 0
  s_waitcnt lgkmcnt(0)
  s_mov_b32 s8, s52
  s_mov_b32 s9, s53
  s_mov_b32 s10, 2097152
  s_mov_b32 s11, 0x20000
  s_cmp_lt_u32 s32, 2
  s_cselect_b32 s12, s58, s60
  s_cselect_b32 s13, s59, s61
  s_cselect_b32 s16, s72, s74
  s_cselect_b32 s17, s73, s75
  s_mov_b32 s14, 524288
  s_mov_b32 s15, 0x20000
  s_mov_b32 s20, s82
  s_mov_b32 s21, s83
  s_mov_b32 s22, 16777216
  s_mov_b32 s23, 0x20000
  s_add_u32 s45, s35, 0
  s_and_b32 s45, s45, 7
  s_lshl_b32 s45, s45, 7
  s_add_u32 s42, s36, s45
  s_add_u32 s43, s37, s45
  s_add_u32 m0, s39, 28928
  s_nop 0
  buffer_load_dwordx4 v176, s[8:11], s42 offen offset:0 lds
  buffer_load_dwordx4 v177, s[8:11], s42 offen offset:1024 lds
  buffer_load_dwordx4 v178, s[8:11], s42 offen offset:2048 lds
  buffer_load_dwordx4 v179, s[8:11], s42 offen offset:3072 lds
  s_add_u32 m0, s40, 28928
  s_nop 0
  buffer_load_dwordx4 v180, s[12:15], s43 offen offset:0 lds
  buffer_load_dwordx4 v181, s[12:15], s43 offen offset:1024 lds
  buffer_load_dword v78, v184, s[20:23], 0 offen sc1
  global_load_ushort v80, v185, s[54:55]
  global_load_ushort v81, v185, s[56:57]
  global_load_ushort v82, v185, s[66:67]
  s_add_u32 s45, s35, 1
  s_and_b32 s45, s45, 7
  s_lshl_b32 s45, s45, 7
  s_add_u32 s42, s36, s45
  s_add_u32 s43, s37, s45
  s_add_u32 m0, s39, 71936
  s_nop 0
  buffer_load_dwordx4 v176, s[8:11], s42 offen offset:0 lds
  buffer_load_dwordx4 v177, s[8:11], s42 offen offset:1024 lds
  buffer_load_dwordx4 v178, s[8:11], s42 offen offset:2048 lds
  buffer_load_dwordx4 v179, s[8:11], s42 offen offset:3072 lds
  s_add_u32 m0, s40, 71936
  s_nop 0
  buffer_load_dwordx4 v180, s[12:15], s43 offen offset:0 lds
  buffer_load_dwordx4 v181, s[12:15], s43 offen offset:1024 lds
  s_mov_b32 s18, 1835008
  s_mov_b32 s19, 0x20000
  s_mov_b32 s24, s80
  s_mov_b32 s25, s81
  s_mov_b32 s26, 256
  s_mov_b32 s27, 0x20000
  s_mov_b32 s49, 0
  s_lshl_b32 s45, s33, 2
  s_add_u32 s45, s45, s32
  s_mul_i32 s46, s45, 112
  s_mul_i32 s47, s34, 7
  s_add_u32 s46, s46, s47
  s_lshl_b32 s46, s46, 10
  s_add_u32 s92, s46, 5242880
  s_lshl_b32 s46, s45, 4
  s_add_u32 s46, s46, s34
  s_lshl_b32 s46, s46, 12
  s_add_u32 s93, s46, 1048576
  v_lshrrev_b32 v184, 5, v1
  v_lshlrev_b32 v15, 4, v1
  s_lshl_b32 s45, s32, 1
  v_add_u32_e64 v14, s45, v184
  v_bfe_u32 v185, v13, 1, 3
  v_xor_b32 v185, v185, v184
  v_lshlrev_b32 v186, 7, v13
  s_add_u32 s45, s32, 0
  s_and_b32 s45, s45, 3
  s_lshl_b32 s46, s45, 1
  v_xor_b32 v187, s46, v185
  v_lshl_add_u32 v187, v187, 4, v186
  v_add_u32 v187, 0x7100, v187
  v_add_u32_e64 v168, s39, v187
  v_add_u32 v172, 0x4000, v187
  s_add_u32 s45, s32, 1
  s_and_b32 s45, s45, 3
  s_lshl_b32 s46, s45, 1
  v_xor_b32 v187, s46, v185
  v_lshl_add_u32 v187, v187, 4, v186
  v_add_u32 v187, 0x7100, v187
  v_add_u32_e64 v169, s39, v187
  v_add_u32 v173, 0x4000, v187
  s_add_u32 s45, s32, 2
  s_and_b32 s45, s45, 3
  s_lshl_b32 s46, s45, 1
  v_xor_b32 v187, s46, v185
  v_lshl_add_u32 v187, v187, 4, v186
  v_add_u32 v187, 0x7100, v187
  v_add_u32_e64 v170, s39, v187
  v_add_u32 v174, 0x4000, v187
  s_add_u32 s45, s32, 3
  s_and_b32 s45, s45, 3
  s_lshl_b32 s46, s45, 1
  v_xor_b32 v187, s46, v185
  v_lshl_add_u32 v187, v187, 4, v186
  v_add_u32 v187, 0x7100, v187
  v_add_u32_e64 v171, s39, v187
  v_add_u32 v175, 0x4000, v187
  v_add_u32_e64 v184, 0, v1
  v_mul_u32_u24 v185, 0x124a, v184
  v_lshrrev_b32 v185, 16, v185
  v_mul_u32_u24 v186, 14, v185
  v_sub_u32_e64 v186, v184, v186
  v_mul_u32_u24 v185, 0xe00, v185
  v_lshl_add_u32 v6, v186, 4, v185
  v_add_u32_e64 v184, 64, v1
  v_mul_u32_u24 v185, 0x124a, v184
  v_lshrrev_b32 v185, 16, v185
  v_mul_u32_u24 v186, 14, v185
  v_sub_u32_e64 v186, v184, v186
  v_mul_u32_u24 v185, 0xe00, v185
  v_lshl_add_u32 v7, v186, 4, v185
  v_subrev_u32 v7, 0x400, v7
  v_add_u32 v184, 128, v1
  v_mul_u32_u24 v185, 0x124a, v184
  v_lshrrev_b32 v185, 16, v185
  v_mul_u32_u24 v186, 14, v185
  v_sub_u32_e64 v186, v184, v186
  v_mul_u32_u24 v185, 0xe00, v185
  v_lshl_add_u32 v8, v186, 4, v185
  v_subrev_u32 v8, 0x800, v8
  v_add_u32 v184, 192, v1
  v_mul_u32_u24 v185, 0x124a, v184
  v_lshrrev_b32 v185, 16, v185
  v_mul_u32_u24 v186, 14, v185
  v_sub_u32_e64 v186, v184, v186
  v_mul_u32_u24 v185, 0xe00, v185
  v_lshl_add_u32 v9, v186, 4, v185
  v_subrev_u32 v9, 0xc00, v9
  v_add_u32 v184, 256, v1
  v_mul_u32_u24 v185, 0x124a, v184
  v_lshrrev_b32 v185, 16, v185
  v_mul_u32_u24 v186, 14, v185
  v_sub_u32_e64 v186, v184, v186
  v_mul_u32_u24 v185, 0xe00, v185
  v_lshl_add_u32 v10, v186, 4, v185
  v_add_u32 v184, 320, v1
  v_mul_u32_u24 v185, 0x124a, v184
  v_lshrrev_b32 v185, 16, v185
  v_mul_u32_u24 v186, 14, v185
  v_sub_u32_e64 v186, v184, v186
  v_mul_u32_u24 v185, 0xe00, v185
  v_lshl_add_u32 v11, v186, 4, v185
  v_subrev_u32 v11, 0x400, v11
  v_add_u32 v184, 384, v1
  v_mul_u32_u24 v185, 0x124a, v184
  v_lshrrev_b32 v185, 16, v185
  v_mul_u32_u24 v186, 14, v185
  v_sub_u32_e64 v186, v184, v186
  v_mul_u32_u24 v185, 0xe00, v185
  v_lshl_add_u32 v12, v186, 4, v185
  v_subrev_u32 v12, 0x800, v12
  v_lshrrev_b32 v184, 4, v1
  v_and_b32 v185, 1, v184
  v_lshrrev_b32_e64 v186, 1, v184
  v_bfe_u32 v187, v1, 2, 2
  v_and_b32 v188, 3, v1
  v_and_b32 v189, 1, v188
  v_lshrrev_b32_e64 v190, 1, v188
  v_lshl_add_u32 v191, v189, 1, v190
  v_lshl_add_u32 v192, v186, 3, v187
  v_mul_u32_u24 v193, 224, v192
  v_lshl_add_u32 v193, v191, 3, v193
  v_mul_u32_u24 v194, 0x3880, v185
  v_add_u32_e64 v193, v193, v194
  s_add_u32 s45, s32, 0
  s_and_b32 s45, s45, 3
  s_mul_i32 s45, s45, 3584
  s_add_u32 s45, s45, 129792
  v_add_u32_e64 v2, s45, v193
  s_add_u32 s45, s32, 1
  s_and_b32 s45, s45, 3
  s_mul_i32 s45, s45, 3584
  s_add_u32 s45, s45, 129792
  v_add_u32_e64 v3, s45, v193
  s_add_u32 s45, s32, 2
  s_and_b32 s45, s45, 3
  s_mul_i32 s45, s45, 3584
  s_add_u32 s45, s45, 129792
  v_add_u32_e64 v4, s45, v193
  s_add_u32 s45, s32, 3
  s_and_b32 s45, s45, 3
  s_mul_i32 s45, s45, 3584
  s_add_u32 s45, s45, 129792
  v_add_u32 v5, s45, v193
  v_and_b32 v193, 15, v1
  v_cmp_eq_u32_e64 vcc, v193, v185
  v_mov_b32 v194, 0x3f803f80
  s_nop 0
  v_cndmask_b32 v196, 0, v194, vcc
  v_accvgpr_write_b32 a180, v196
  v_accvgpr_write_b32 a181, v196
  v_accvgpr_write_b32 a182, v196
  v_accvgpr_write_b32 a183, v196
  v_accvgpr_write_b32 a184, v194
  v_accvgpr_write_b32 a185, v194
  s_lshl_b32 s45, s32, 2
  s_add_u32 s45, s45, 57856
  v_add_u32 v193, s45, v15
  v_lshlrev_b32_e64 v194, 2, v1
  v_add_u32 v194, 0xf000, v194
  v_cmp_gt_u32 vcc, 16, v1
  s_nop 1
  v_cndmask_b32 v58, v194, v193, vcc
  v_lshlrev_b32 v59, 4, v13
  v_add_u32 v59, 0xe200, v59
  v_lshlrev_b32_e64 v69, 3, v13
  v_lshl_add_u32 v68, v14, 8, v69
  v_add_u32 v68, 0xf400, v68
  v_add_u32 v69, 0xf400, v69
  v_lshrrev_b32_e64 v195, 5, v1
  v_bfe_u32 v193, v13, 2, 1
  v_lshlrev_b32 v193, 4, v193
  v_lshrrev_b32 v194, 3, v13
  v_lshl_add_u32 v193, v194, 2, v193
  v_and_b32 v194, 3, v13
  v_add_u32 v193, v193, v194
  s_lshl_b32 s45, s32, 7
  s_add_u32 s45, s45, 66560
  v_lshl_add_u32 v76, v193, 2, s45
  v_lshl_add_u32 v77, v195, 6, s45
  s_lshr_b32 s45, s36, 7
  s_add_u32 s45, s45, 262144
  s_and_b32 s46, s34, 3
  s_cmp_eq_u32 s46, 0
  s_cselect_b32 s45, s45, 0x70000000
  v_lshl_add_u32 v75, v193, 3, s45
  v_mov_b32 v194, 0x70000000
  v_cmp_gt_u32 vcc, 32, v1
  s_nop 1
  v_cndmask_b32_e64 v75, v194, v75, vcc
  s_lshl_b32 s45, s33, 4
  s_add_u32 s45, s45, s34
  s_lshl_b32 s45, s45, 9
  s_add_u32 s45, s45, 4096
  s_cmp_eq_u32 s32, 0
  s_cselect_b32 s45, s45, 0x70000000
  v_lshl_add_u32 v70, v13, 4, s45
  v_cndmask_b32 v70, v194, v70, vcc
  v_mov_b32 v61, 0
  v_mov_b32 v65, 0
  v_mov_b32 v62, 0
  v_mov_b32 v66, 0
  v_mov_b32 v63, 0
  v_mov_b32 v67, 0
  s_waitcnt vmcnt(8)
  v_lshlrev_b32 v80, 16, v80
  s_waitcnt vmcnt(7)
  v_lshlrev_b32 v81, 16, v81
  s_waitcnt vmcnt(6)
  v_lshlrev_b32_e64 v82, 16, v82
  v_mul_f32 v82, 0x3fb8aa3b, v82
  v_exp_f32 v82, v82
  s_nop 0
  v_cvt_pk_bf16_f32 v82, v82, v82
  v_lshlrev_b32 v82, 16, v82
  v_mul_f32 v83, v82, v80
  v_mul_f32_e64 v84, v82, v81
  v_mul_f32 v42, 0x3fb8aa3b, v83
  v_mul_f32 v43, 0x3e22f983, v84
  v_mov_b32 v85, 1.0
  v_mul_f32 v86, v85, v42
  v_mul_f32 v87, v85, v43
  v_exp_f32 v86, v86
  v_fract_f32 v87, v87
  v_cos_f32 v40, v87
  v_sin_f32 v41, v87
  v_mul_f32 v40, v40, v86
  v_mul_f32 v41, v41, v86
  v_mov_b32 v85, 0x41800000
  v_mul_f32 v86, v85, v42
  v_mul_f32 v87, v85, v43
  v_exp_f32 v86, v86
  v_fract_f32 v87, v87
  v_cos_f32 v46, v87
  v_sin_f32 v47, v87
  v_mul_f32 v46, v46, v86
  v_mul_f32 v47, v47, v86
  v_add_f32 v85, -1.0, v40
  v_mul_f32 v86, v80, v80
  v_fma_f32 v86, v81, v81, v86
  v_rcp_f32 v86, v86
  v_mul_f32 v87, v85, v80
  v_fma_f32 v87, v41, v81, v87
  v_mul_f32_e64 v88, v41, v80
  v_fma_f32 v88, -v85, v81, v88
  v_add_f32 v86, v86, v86
  v_mul_f32 v44, v87, v86
  v_mul_f32 v45, v88, v86
  v_add_u32 v78, 1, v78
  v_cmp_eq_u32 vcc, 0, v78
  s_nop 1
  v_cndmask_b32 v78, v78, 1, vcc
  s_or_b32 s45, s2, s32
  s_cmp_eq_u32 s45, 0
  s_cselect_b32 s45, 0, 0x70000000
  v_cmp_eq_u32_e64 vcc, 0, v1
  v_mov_b32 v193, 0x70000000
  v_mov_b32 v194, s45
  v_cndmask_b32 v193, v193, v194, vcc
  buffer_store_dword v78, v193, s[20:23], 0 offen sc1
  buffer_store_dword v78, v193, s[24:27], 0 offen sc1
  s_add_u32 s45, s35, 2
  s_and_b32 s45, s45, 7
  s_lshl_b32 s45, s45, 7
  s_add_u32 s42, s36, s45
  s_add_u32 s43, s37, s45
  s_add_u32 m0, s39, 100864
  s_nop 0
  buffer_load_dwordx4 v176, s[8:11], s42 offen offset:0 lds
  buffer_load_dwordx4 v177, s[8:11], s42 offen offset:1024 lds
  buffer_load_dwordx4 v178, s[8:11], s42 offen offset:2048 lds
  buffer_load_dwordx4 v179, s[8:11], s42 offen offset:3072 lds
  s_add_u32 m0, s40, 100864
  s_nop 0
  buffer_load_dwordx4 v180, s[12:15], s43 offen offset:0 lds
  buffer_load_dwordx4 v181, s[12:15], s43 offen offset:1024 lds
  s_barrier
  ds_read_b128 a[0:3], v168
  ds_read_b128 v[144:147], v172
  ds_read_b128 v[148:151], v172 offset:4096
  v_add_u32 v168, 0xa800, v168
  v_add_u32 v172, 0xa800, v172
  ds_read_b128 a[4:7], v169
  ds_read_b128 v[152:155], v173
  ds_read_b128 v[156:159], v173 offset:4096
  v_add_u32 v169, 0xa800, v169
  v_add_u32 v173, 0xa800, v173
  s_waitcnt lgkmcnt(3)
  v_mfma_f32_32x32x16_bf16 v[112:127], a[0:3], v[144:147], 0
  ds_read_b128 a[8:11], v170
  ds_read_b128 v[160:163], v174
  ds_read_b128 v[164:167], v174 offset:4096
  v_add_u32 v170, 0xa800, v170
  v_add_u32 v174, 0xa800, v174
  v_mfma_f32_32x32x16_bf16 v[128:143], a[0:3], v[148:151], 0
  s_add_u32 s45, s35, 3
  s_and_b32 s45, s45, 7
  s_lshl_b32 s45, s45, 7
  s_add_u32 s42, s36, s45
  s_add_u32 s43, s37, s45
  s_add_u32 m0, s39, 129792
  s_nop 0
  buffer_load_dwordx4 v176, s[8:11], s42 offen offset:0 lds
  buffer_load_dwordx4 v177, s[8:11], s42 offen offset:1024 lds
  s_waitcnt lgkmcnt(3)
  v_mfma_f32_16x16x32_bf16 a[156:159], a[180:183], v[144:147], 0
  v_mfma_f32_16x16x32_bf16 a[160:163], a[180:183], v[148:151], 0
  v_mfma_f32_4x4x4bf16_1k a[164:167], a[184:185], a[0:1], 0
  v_mfma_f32_4x4x4bf16_1k a[172:175], a[0:1], a[0:1], 0
  v_mfma_f32_4x4x4bf16_1k a[168:171], a[184:185], a[2:3], 0
  v_mfma_f32_4x4x4bf16_1k a[176:179], a[2:3], a[2:3], 0
  v_mfma_f32_32x32x16_bf16 v[112:127], a[4:7], v[152:155], v[112:127]
  ds_read_b128 a[12:15], v171
  ds_read_b128 v[144:147], v175
  ds_read_b128 v[148:151], v175 offset:4096
  v_add_u32 v171, 0xa800, v171
  v_add_u32 v175, 0xa800, v175
  v_mfma_f32_32x32x16_bf16 v[128:143], a[4:7], v[156:159], v[128:143]
  buffer_load_dwordx4 v178, s[8:11], s42 offen offset:2048 lds
  buffer_load_dwordx4 v179, s[8:11], s42 offen offset:3072 lds
  s_waitcnt lgkmcnt(3)
  s_add_u32 m0, s40, 129792
  v_mfma_f32_4x4x4bf16_1k a[164:167], a[184:185], a[4:5], a[164:167]
  v_mfma_f32_4x4x4bf16_1k a[172:175], a[4:5], a[4:5], a[172:175]
  v_mfma_f32_4x4x4bf16_1k a[168:171], a[184:185], a[6:7], a[168:171]
  v_mfma_f32_4x4x4bf16_1k a[176:179], a[6:7], a[6:7], a[176:179]
  v_mfma_f32_32x32x16_bf16 v[112:127], a[8:11], v[160:163], v[112:127]
  buffer_load_dwordx4 v180, s[12:15], s43 offen offset:0 lds
  v_mfma_f32_32x32x16_bf16 v[128:143], a[8:11], v[164:167], v[128:143]
  s_waitcnt vmcnt(13)
  s_barrier
  ds_read_b128 a[16:19], v168
  ds_read_b128 v[152:155], v172
  ds_read_b128 v[156:159], v172 offset:4096
  v_add_u32 v168, 0x7100, v168
  v_add_u32 v172, 0x7100, v172
  s_waitcnt lgkmcnt(3)
  v_mfma_f32_4x4x4bf16_1k a[164:167], a[184:185], a[8:9], a[164:167]
  v_mfma_f32_4x4x4bf16_1k a[172:175], a[8:9], a[8:9], a[172:175]
  v_mfma_f32_4x4x4bf16_1k a[168:171], a[184:185], a[10:11], a[168:171]
  v_mfma_f32_4x4x4bf16_1k a[176:179], a[10:11], a[10:11], a[176:179]
  v_mfma_f32_32x32x16_bf16 v[112:127], a[12:15], v[144:147], v[112:127]
  ds_read_b128 a[20:23], v169
  ds_read_b128 v[160:163], v173
  ds_read_b128 v[164:167], v173 offset:4096
  v_add_u32 v169, 0x7100, v169
  v_add_u32 v173, 0x7100, v173
  v_mfma_f32_32x32x16_bf16 v[128:143], a[12:15], v[148:151], v[128:143]
  buffer_load_dwordx4 v181, s[12:15], s43 offen offset:1024 lds
  s_add_u32 s45, s35, 4
  s_and_b32 s45, s45, 7
  s_lshl_b32 s45, s45, 7
  s_add_u32 s42, s36, s45
  s_add_u32 s43, s37, s45
  s_add_u32 m0, s39, 0
  s_nop 0
  buffer_load_dwordx4 v176, s[8:11], s42 offen offset:0 lds
  s_waitcnt lgkmcnt(3)
  v_mfma_f32_4x4x4bf16_1k a[164:167], a[184:185], a[12:13], a[164:167]
  v_mfma_f32_4x4x4bf16_1k a[172:175], a[12:13], a[12:13], a[172:175]
  v_mfma_f32_4x4x4bf16_1k a[168:171], a[184:185], a[14:15], a[168:171]
  v_mfma_f32_4x4x4bf16_1k a[176:179], a[14:15], a[14:15], a[176:179]
  v_mfma_f32_32x32x16_bf16 v[112:127], a[16:19], v[152:155], v[112:127]
  ds_read_b128 a[24:27], v170
  ds_read_b128 v[144:147], v174
  ds_read_b128 v[148:151], v174 offset:4096
  v_add_u32 v170, 0x7100, v170
  v_add_u32 v174, 0x7100, v174
  v_mfma_f32_32x32x16_bf16 v[128:143], a[16:19], v[156:159], v[128:143]
  buffer_load_dwordx4 v177, s[8:11], s42 offen offset:1024 lds
  buffer_load_dwordx4 v178, s[8:11], s42 offen offset:2048 lds
  s_waitcnt lgkmcnt(3)
  v_mfma_f32_16x16x32_bf16 a[156:159], a[180:183], v[152:155], a[156:159]
  v_mfma_f32_16x16x32_bf16 a[160:163], a[180:183], v[156:159], a[160:163]
  v_mfma_f32_4x4x4bf16_1k a[164:167], a[184:185], a[16:17], a[164:167]
  v_mfma_f32_4x4x4bf16_1k a[172:175], a[16:17], a[16:17], a[172:175]
  v_mfma_f32_4x4x4bf16_1k a[168:171], a[184:185], a[18:19], a[168:171]
  v_mfma_f32_4x4x4bf16_1k a[176:179], a[18:19], a[18:19], a[176:179]
  v_mfma_f32_32x32x16_bf16 v[112:127], a[20:23], v[160:163], v[112:127]
  ds_read_b128 a[28:31], v171
  ds_read_b128 v[152:155], v175
  ds_read_b128 v[156:159], v175 offset:4096
  v_add_u32 v171, 0x7100, v171
  v_add_u32 v175, 0x7100, v175
  v_mfma_f32_32x32x16_bf16 v[128:143], a[20:23], v[164:167], v[128:143]
  buffer_load_dwordx4 v179, s[8:11], s42 offen offset:3072 lds
  s_add_u32 m0, s40, 0
  s_nop 0
  buffer_load_dwordx4 v180, s[12:15], s43 offen offset:0 lds
  s_waitcnt lgkmcnt(3)
  v_mfma_f32_4x4x4bf16_1k a[164:167], a[184:185], a[20:21], a[164:167]
  v_mfma_f32_4x4x4bf16_1k a[172:175], a[20:21], a[20:21], a[172:175]
  v_mfma_f32_4x4x4bf16_1k a[168:171], a[184:185], a[22:23], a[168:171]
  v_mfma_f32_4x4x4bf16_1k a[176:179], a[22:23], a[22:23], a[176:179]
  v_mfma_f32_32x32x16_bf16 v[112:127], a[24:27], v[144:147], v[112:127]
  buffer_load_dwordx4 v181, s[12:15], s43 offen offset:1024 lds
  v_mfma_f32_32x32x16_bf16 v[128:143], a[24:27], v[148:151], v[128:143]
  s_waitcnt vmcnt(12)
  s_barrier
  ds_read_b128 a[32:35], v168
  ds_read_b128 v[160:163], v172
  ds_read_b128 v[164:167], v172 offset:4096
  v_add_u32 v168, 0x7100, v168
  v_add_u32 v172, 0x7100, v172
  s_waitcnt lgkmcnt(3)
  s_add_u32 s45, s35, 5
  s_and_b32 s45, s45, 7
  s_lshl_b32 s45, s45, 7
  s_add_u32 s42, s36, s45
  s_add_u32 s43, s37, s45
  s_add_u32 m0, s39, 28928
  v_mfma_f32_4x4x4bf16_1k a[164:167], a[184:185], a[24:25], a[164:167]
  v_mfma_f32_4x4x4bf16_1k a[172:175], a[24:25], a[24:25], a[172:175]
  v_mfma_f32_4x4x4bf16_1k a[168:171], a[184:185], a[26:27], a[168:171]
  v_mfma_f32_4x4x4bf16_1k a[176:179], a[26:27], a[26:27], a[176:179]
  v_mfma_f32_32x32x16_bf16 v[112:127], a[28:31], v[152:155], v[112:127]
  ds_read_b128 a[36:39], v169
  ds_read_b128 v[144:147], v173
  ds_read_b128 v[148:151], v173 offset:4096
  v_add_u32 v169, 0x7100, v169
  v_add_u32 v173, 0x7100, v173
  v_mfma_f32_32x32x16_bf16 v[128:143], a[28:31], v[156:159], v[128:143]
  buffer_load_dwordx4 v176, s[8:11], s42 offen offset:0 lds
  buffer_load_dwordx4 v177, s[8:11], s42 offen offset:1024 lds
  s_waitcnt lgkmcnt(3)
  v_mfma_f32_4x4x4bf16_1k a[164:167], a[184:185], a[28:29], a[164:167]
  v_mfma_f32_4x4x4bf16_1k a[172:175], a[28:29], a[28:29], a[172:175]
  v_mfma_f32_4x4x4bf16_1k a[168:171], a[184:185], a[30:31], a[168:171]
  v_mfma_f32_4x4x4bf16_1k a[176:179], a[30:31], a[30:31], a[176:179]
  v_mfma_f32_32x32x16_bf16 v[112:127], a[32:35], v[160:163], v[112:127]
  ds_read_b128 a[40:43], v170
  ds_read_b128 v[152:155], v174
  ds_read_b128 v[156:159], v174 offset:4096
  v_add_u32 v170, 0x7100, v170
  v_add_u32 v174, 0x7100, v174
  v_mfma_f32_32x32x16_bf16 v[128:143], a[32:35], v[164:167], v[128:143]
  buffer_load_dwordx4 v178, s[8:11], s42 offen offset:2048 lds
  buffer_load_dwordx4 v179, s[8:11], s42 offen offset:3072 lds
  s_waitcnt lgkmcnt(3)
  s_add_u32 m0, s40, 28928
  v_mfma_f32_16x16x32_bf16 a[156:159], a[180:183], v[160:163], a[156:159]
  v_mfma_f32_16x16x32_bf16 a[160:163], a[180:183], v[164:167], a[160:163]
  v_mfma_f32_4x4x4bf16_1k a[164:167], a[184:185], a[32:33], a[164:167]
  v_mfma_f32_4x4x4bf16_1k a[172:175], a[32:33], a[32:33], a[172:175]
  v_mfma_f32_4x4x4bf16_1k a[168:171], a[184:185], a[34:35], a[168:171]
  v_mfma_f32_4x4x4bf16_1k a[176:179], a[34:35], a[34:35], a[176:179]
  v_mfma_f32_32x32x16_bf16 v[112:127], a[36:39], v[144:147], v[112:127]
  ds_read_b128 a[44:47], v171
  ds_read_b128 v[160:163], v175
  ds_read_b128 v[164:167], v175 offset:4096
  v_add_u32 v171, 0x7100, v171
  v_add_u32 v175, 0x7100, v175
  v_mfma_f32_32x32x16_bf16 v[128:143], a[36:39], v[148:151], v[128:143]
  buffer_load_dwordx4 v180, s[12:15], s43 offen offset:0 lds
  buffer_load_dwordx4 v181, s[12:15], s43 offen offset:1024 lds
  s_waitcnt lgkmcnt(3)
  v_mfma_f32_4x4x4bf16_1k a[164:167], a[184:185], a[36:37], a[164:167]
  v_mfma_f32_4x4x4bf16_1k a[172:175], a[36:37], a[36:37], a[172:175]
  v_mfma_f32_4x4x4bf16_1k a[168:171], a[184:185], a[38:39], a[168:171]
  v_mfma_f32_4x4x4bf16_1k a[176:179], a[38:39], a[38:39], a[176:179]
  v_mfma_f32_32x32x16_bf16 v[112:127], a[40:43], v[152:155], v[112:127]
  v_mfma_f32_32x32x16_bf16 v[128:143], a[40:43], v[156:159], v[128:143]
  s_waitcnt vmcnt(12)
  s_barrier
  ds_read_b128 a[48:51], v168
  ds_read_b128 v[144:147], v172
  ds_read_b128 v[148:151], v172 offset:4096
  v_add_u32 v168, 0xfffe0500, v168
  v_add_u32 v172, 0xfffe0500, v172
  s_waitcnt lgkmcnt(3)
  s_add_u32 s45, s35, 6
  s_and_b32 s45, s45, 7
  s_lshl_b32 s45, s45, 7
  s_add_u32 s42, s36, s45
  s_add_u32 s43, s37, s45
  s_add_u32 m0, s39, 71936
  v_mfma_f32_4x4x4bf16_1k a[164:167], a[184:185], a[40:41], a[164:167]
  v_mfma_f32_4x4x4bf16_1k a[172:175], a[40:41], a[40:41], a[172:175]
  v_mfma_f32_4x4x4bf16_1k a[168:171], a[184:185], a[42:43], a[168:171]
  v_mfma_f32_4x4x4bf16_1k a[176:179], a[42:43], a[42:43], a[176:179]
  v_mfma_f32_32x32x16_bf16 v[112:127], a[44:47], v[160:163], v[112:127]
  ds_read_b128 a[52:55], v169
  ds_read_b128 v[152:155], v173
  ds_read_b128 v[156:159], v173 offset:4096
  v_add_u32 v169, 0xfffe0500, v169
  v_add_u32 v173, 0xfffe0500, v173
  v_mfma_f32_32x32x16_bf16 v[128:143], a[44:47], v[164:167], v[128:143]
  buffer_load_dwordx4 v176, s[8:11], s42 offen offset:0 lds
  buffer_load_dwordx4 v177, s[8:11], s42 offen offset:1024 lds
  s_waitcnt lgkmcnt(3)
  v_mfma_f32_4x4x4bf16_1k a[164:167], a[184:185], a[44:45], a[164:167]
  v_mfma_f32_4x4x4bf16_1k a[172:175], a[44:45], a[44:45], a[172:175]
  v_mfma_f32_4x4x4bf16_1k a[168:171], a[184:185], a[46:47], a[168:171]
  v_mfma_f32_4x4x4bf16_1k a[176:179], a[46:47], a[46:47], a[176:179]
  v_mfma_f32_32x32x16_bf16 v[112:127], a[48:51], v[144:147], v[112:127]
  ds_read_b128 a[56:59], v170
  ds_read_b128 v[160:163], v174
  ds_read_b128 v[164:167], v174 offset:4096
  v_add_u32 v170, 0xfffe0500, v170
  v_add_u32 v174, 0xfffe0500, v174
  v_mfma_f32_32x32x16_bf16 v[128:143], a[48:51], v[148:151], v[128:143]
  buffer_load_dwordx4 v178, s[8:11], s42 offen offset:2048 lds
  buffer_load_dwordx4 v179, s[8:11], s42 offen offset:3072 lds
  s_waitcnt lgkmcnt(3)
  s_add_u32 m0, s40, 71936
  v_mfma_f32_16x16x32_bf16 a[156:159], a[180:183], v[144:147], a[156:159]
  v_mfma_f32_16x16x32_bf16 a[160:163], a[180:183], v[148:151], a[160:163]
  v_mfma_f32_4x4x4bf16_1k a[164:167], a[184:185], a[48:49], a[164:167]
  v_mfma_f32_4x4x4bf16_1k a[172:175], a[48:49], a[48:49], a[172:175]
  v_mfma_f32_4x4x4bf16_1k a[168:171], a[184:185], a[50:51], a[168:171]
  v_mfma_f32_4x4x4bf16_1k a[176:179], a[50:51], a[50:51], a[176:179]
  v_mfma_f32_32x32x16_bf16 v[112:127], a[52:55], v[152:155], v[112:127]
  ds_read_b128 a[60:63], v171
  ds_read_b128 v[144:147], v175
  ds_read_b128 v[148:151], v175 offset:4096
  v_add_u32 v171, 0xfffe0500, v171
  v_add_u32 v175, 0xfffe0500, v175
  v_mfma_f32_32x32x16_bf16 v[128:143], a[52:55], v[156:159], v[128:143]
  buffer_load_dwordx4 v180, s[12:15], s43 offen offset:0 lds
  buffer_load_dwordx4 v181, s[12:15], s43 offen offset:1024 lds
  s_waitcnt lgkmcnt(3)
  v_mfma_f32_4x4x4bf16_1k a[164:167], a[184:185], a[52:53], a[164:167]
  v_mfma_f32_4x4x4bf16_1k a[172:175], a[52:53], a[52:53], a[172:175]
  v_mfma_f32_4x4x4bf16_1k a[168:171], a[184:185], a[54:55], a[168:171]
  v_mfma_f32_4x4x4bf16_1k a[176:179], a[54:55], a[54:55], a[176:179]
  v_mfma_f32_32x32x16_bf16 v[112:127], a[56:59], v[160:163], v[112:127]
  v_mfma_f32_32x32x16_bf16 v[128:143], a[56:59], v[164:167], v[128:143]
  s_waitcnt vmcnt(12)
  s_barrier
  ds_read_b128 a[64:67], v168
  ds_read_b128 v[152:155], v172
  ds_read_b128 v[156:159], v172 offset:4096
  v_add_u32 v168, 0x7100, v168
  v_add_u32 v172, 0x7100, v172
  s_waitcnt lgkmcnt(3)
  s_add_u32 s45, s35, 7
  s_and_b32 s45, s45, 7
  s_lshl_b32 s45, s45, 7
  s_add_u32 s42, s36, s45
  s_add_u32 s43, s37, s45
  s_add_u32 m0, s39, 100864
  v_mfma_f32_4x4x4bf16_1k a[164:167], a[184:185], a[56:57], a[164:167]
  v_mfma_f32_4x4x4bf16_1k a[172:175], a[56:57], a[56:57], a[172:175]
  v_mfma_f32_4x4x4bf16_1k a[168:171], a[184:185], a[58:59], a[168:171]
  v_mfma_f32_4x4x4bf16_1k a[176:179], a[58:59], a[58:59], a[176:179]
  v_mfma_f32_32x32x16_bf16 v[112:127], a[60:63], v[144:147], v[112:127]
  ds_read_b128 a[68:71], v169
  ds_read_b128 v[160:163], v173
  ds_read_b128 v[164:167], v173 offset:4096
  v_add_u32 v169, 0x7100, v169
  v_add_u32 v173, 0x7100, v173
  v_mfma_f32_32x32x16_bf16 v[128:143], a[60:63], v[148:151], v[128:143]
  buffer_load_dwordx4 v176, s[8:11], s42 offen offset:0 lds
  buffer_load_dwordx4 v177, s[8:11], s42 offen offset:1024 lds
  s_waitcnt lgkmcnt(3)
  v_mfma_f32_4x4x4bf16_1k a[164:167], a[184:185], a[60:61], a[164:167]
  v_mfma_f32_4x4x4bf16_1k a[172:175], a[60:61], a[60:61], a[172:175]
  v_mfma_f32_4x4x4bf16_1k a[168:171], a[184:185], a[62:63], a[168:171]
  v_mfma_f32_4x4x4bf16_1k a[176:179], a[62:63], a[62:63], a[176:179]
  v_mfma_f32_32x32x16_bf16 v[112:127], a[64:67], v[152:155], v[112:127]
  ds_read_b128 a[72:75], v170
  ds_read_b128 v[144:147], v174
  ds_read_b128 v[148:151], v174 offset:4096
  v_add_u32 v170, 0x7100, v170
  v_add_u32 v174, 0x7100, v174
  v_mfma_f32_32x32x16_bf16 v[128:143], a[64:67], v[156:159], v[128:143]
  buffer_load_dwordx4 v178, s[8:11], s42 offen offset:2048 lds
  buffer_load_dwordx4 v179, s[8:11], s42 offen offset:3072 lds
  s_waitcnt lgkmcnt(3)
  s_add_u32 m0, s40, 100864
  v_mfma_f32_16x16x32_bf16 a[156:159], a[180:183], v[152:155], a[156:159]
  v_mfma_f32_16x16x32_bf16 a[160:163], a[180:183], v[156:159], a[160:163]
  v_mfma_f32_4x4x4bf16_1k a[164:167], a[184:185], a[64:65], a[164:167]
  v_mfma_f32_4x4x4bf16_1k a[172:175], a[64:65], a[64:65], a[172:175]
  v_mfma_f32_4x4x4bf16_1k a[168:171], a[184:185], a[66:67], a[168:171]
  v_mfma_f32_4x4x4bf16_1k a[176:179], a[66:67], a[66:67], a[176:179]
  v_mfma_f32_32x32x16_bf16 v[112:127], a[68:71], v[160:163], v[112:127]
  ds_read_b128 a[76:79], v171
  ds_read_b128 v[152:155], v175
  ds_read_b128 v[156:159], v175 offset:4096
  v_add_u32 v171, 0x7100, v171
  v_add_u32 v175, 0x7100, v175
  v_mfma_f32_32x32x16_bf16 v[128:143], a[68:71], v[164:167], v[128:143]
  buffer_load_dwordx4 v180, s[12:15], s43 offen offset:0 lds
  buffer_load_dwordx4 v181, s[12:15], s43 offen offset:1024 lds
  s_waitcnt lgkmcnt(3)
  v_mfma_f32_4x4x4bf16_1k a[164:167], a[184:185], a[68:69], a[164:167]
  v_mfma_f32_4x4x4bf16_1k a[172:175], a[68:69], a[68:69], a[172:175]
  v_mfma_f32_4x4x4bf16_1k a[168:171], a[184:185], a[70:71], a[168:171]
  v_mfma_f32_4x4x4bf16_1k a[176:179], a[70:71], a[70:71], a[176:179]
  v_mfma_f32_32x32x16_bf16 v[112:127], a[72:75], v[144:147], v[112:127]
  v_mfma_f32_32x32x16_bf16 v[128:143], a[72:75], v[148:151], v[128:143]
  s_waitcnt vmcnt(12)
  s_barrier
  ds_read_b128 a[80:83], v168
  ds_read_b128 v[160:163], v172
  ds_read_b128 v[164:167], v172 offset:4096
  v_add_u32 v168, 0xa800, v168
  v_add_u32 v172, 0xa800, v172
  s_waitcnt lgkmcnt(3)
  s_add_u32 s45, s35, 0
  s_and_b32 s45, s45, 7
  s_mul_i32 s45, s45, 229376
  s_add_u32 s44, s38, s45
  s_add_u32 m0, s41, 129792
  v_mfma_f32_4x4x4bf16_1k a[164:167], a[184:185], a[72:73], a[164:167]
  v_mfma_f32_4x4x4bf16_1k a[172:175], a[72:73], a[72:73], a[172:175]
  v_mfma_f32_4x4x4bf16_1k a[168:171], a[184:185], a[74:75], a[168:171]
  v_mfma_f32_4x4x4bf16_1k a[176:179], a[74:75], a[74:75], a[176:179]
  v_mfma_f32_32x32x16_bf16 v[112:127], a[76:79], v[152:155], v[112:127]
  ds_read_b128 a[84:87], v169
  ds_read_b128 v[144:147], v173
  ds_read_b128 v[148:151], v173 offset:4096
  v_add_u32 v169, 0xa800, v169
  v_add_u32 v173, 0xa800, v173
  v_mfma_f32_32x32x16_bf16 v[128:143], a[76:79], v[156:159], v[128:143]
  buffer_load_dwordx4 v6, s[16:19], s44 offen offset:0 lds
  buffer_load_dwordx4 v7, s[16:19], s44 offen offset:1024 lds
  s_waitcnt lgkmcnt(3)
  v_mfma_f32_4x4x4bf16_1k a[164:167], a[184:185], a[76:77], a[164:167]
  v_mfma_f32_4x4x4bf16_1k a[172:175], a[76:77], a[76:77], a[172:175]
  v_mfma_f32_4x4x4bf16_1k a[168:171], a[184:185], a[78:79], a[168:171]
  v_mfma_f32_4x4x4bf16_1k a[176:179], a[78:79], a[78:79], a[176:179]
  v_mfma_f32_32x32x16_bf16 v[112:127], a[80:83], v[160:163], v[112:127]
  ds_read_b128 a[88:91], v170
  ds_read_b128 v[152:155], v174
  ds_read_b128 v[156:159], v174 offset:4096
  v_add_u32 v170, 0xa800, v170
  v_add_u32 v174, 0xa800, v174
  v_mfma_f32_32x32x16_bf16 v[128:143], a[80:83], v[164:167], v[128:143]
  buffer_load_dwordx4 v8, s[16:19], s44 offen offset:2048 lds
  buffer_load_dwordx4 v9, s[16:19], s44 offen offset:3072 lds
  s_waitcnt lgkmcnt(3)
  s_add_u32 m0, s41, 133888
  v_mfma_f32_16x16x32_bf16 a[156:159], a[180:183], v[160:163], a[156:159]
  v_mfma_f32_16x16x32_bf16 a[160:163], a[180:183], v[164:167], a[160:163]
  v_mfma_f32_4x4x4bf16_1k a[164:167], a[184:185], a[80:81], a[164:167]
  v_mfma_f32_4x4x4bf16_1k a[172:175], a[80:81], a[80:81], a[172:175]
  v_mfma_f32_4x4x4bf16_1k a[168:171], a[184:185], a[82:83], a[168:171]
  v_mfma_f32_4x4x4bf16_1k a[176:179], a[82:83], a[82:83], a[176:179]
  v_mfma_f32_32x32x16_bf16 v[112:127], a[84:87], v[144:147], v[112:127]
  ds_read_b128 a[92:95], v171
  ds_read_b128 v[160:163], v175
  ds_read_b128 v[164:167], v175 offset:4096
  v_add_u32 v171, 0xa800, v171
  v_add_u32 v175, 0xa800, v175
  v_mfma_f32_32x32x16_bf16 v[128:143], a[84:87], v[148:151], v[128:143]
  buffer_load_dwordx4 v10, s[16:19], s44 offen offset:0 lds
  buffer_load_dwordx4 v11, s[16:19], s44 offen offset:1024 lds
  s_waitcnt lgkmcnt(3)
  v_mfma_f32_4x4x4bf16_1k a[164:167], a[184:185], a[84:85], a[164:167]
  v_mfma_f32_4x4x4bf16_1k a[172:175], a[84:85], a[84:85], a[172:175]
  v_mfma_f32_4x4x4bf16_1k a[168:171], a[184:185], a[86:87], a[168:171]
  v_mfma_f32_4x4x4bf16_1k a[176:179], a[86:87], a[86:87], a[176:179]
  v_mfma_f32_32x32x16_bf16 v[112:127], a[88:91], v[152:155], v[112:127]
  buffer_load_dwordx4 v12, s[16:19], s44 offen offset:2048 lds
  v_mfma_f32_32x32x16_bf16 v[128:143], a[88:91], v[156:159], v[128:143]
  s_waitcnt vmcnt(13)
  s_barrier
  ds_read_b128 a[96:99], v168
  ds_read_b128 v[144:147], v172
  ds_read_b128 v[148:151], v172 offset:4096
  v_add_u32 v168, 0x7100, v168
  v_add_u32 v172, 0x7100, v172
  s_waitcnt lgkmcnt(3)
  s_add_u32 s45, s35, 1
  s_and_b32 s45, s45, 7
  s_mul_i32 s45, s45, 229376
  s_add_u32 s44, s38, s45
  s_add_u32 m0, s41, 0
  v_mfma_f32_4x4x4bf16_1k a[164:167], a[184:185], a[88:89], a[164:167]
  v_mfma_f32_4x4x4bf16_1k a[172:175], a[88:89], a[88:89], a[172:175]
  v_mfma_f32_4x4x4bf16_1k a[168:171], a[184:185], a[90:91], a[168:171]
  v_mfma_f32_4x4x4bf16_1k a[176:179], a[90:91], a[90:91], a[176:179]
  v_mfma_f32_32x32x16_bf16 v[112:127], a[92:95], v[160:163], v[112:127]
  ds_read_b128 a[100:103], v169
  ds_read_b128 v[152:155], v173
  ds_read_b128 v[156:159], v173 offset:4096
  v_add_u32 v169, 0x7100, v169
  v_add_u32 v173, 0x7100, v173
  v_mfma_f32_32x32x16_bf16 v[128:143], a[92:95], v[164:167], v[128:143]
  buffer_load_dwordx4 v6, s[16:19], s44 offen offset:0 lds
  buffer_load_dwordx4 v7, s[16:19], s44 offen offset:1024 lds
  s_waitcnt lgkmcnt(3)
  v_mfma_f32_4x4x4bf16_1k a[164:167], a[184:185], a[92:93], a[164:167]
  v_mfma_f32_4x4x4bf16_1k a[172:175], a[92:93], a[92:93], a[172:175]
  v_mfma_f32_4x4x4bf16_1k a[168:171], a[184:185], a[94:95], a[168:171]
  v_mfma_f32_4x4x4bf16_1k a[176:179], a[94:95], a[94:95], a[176:179]
  v_mfma_f32_32x32x16_bf16 v[112:127], a[96:99], v[144:147], v[112:127]
  ds_read_b128 a[104:107], v170
  ds_read_b128 v[160:163], v174
  ds_read_b128 v[164:167], v174 offset:4096
  v_add_u32 v170, 0x7100, v170
  v_add_u32 v174, 0x7100, v174
  v_mfma_f32_32x32x16_bf16 v[128:143], a[96:99], v[148:151], v[128:143]
  buffer_load_dwordx4 v8, s[16:19], s44 offen offset:2048 lds
  buffer_load_dwordx4 v9, s[16:19], s44 offen offset:3072 lds
  s_waitcnt lgkmcnt(3)
  s_add_u32 m0, s41, 4096
  v_mfma_f32_16x16x32_bf16 a[156:159], a[180:183], v[144:147], a[156:159]
  v_mfma_f32_16x16x32_bf16 a[160:163], a[180:183], v[148:151], a[160:163]
  v_mfma_f32_4x4x4bf16_1k a[164:167], a[184:185], a[96:97], a[164:167]
  v_mfma_f32_4x4x4bf16_1k a[172:175], a[96:97], a[96:97], a[172:175]
  v_mfma_f32_4x4x4bf16_1k a[168:171], a[184:185], a[98:99], a[168:171]
  v_mfma_f32_4x4x4bf16_1k a[176:179], a[98:99], a[98:99], a[176:179]
  v_mfma_f32_32x32x16_bf16 v[112:127], a[100:103], v[152:155], v[112:127]
  ds_read_b128 a[108:111], v171
  ds_read_b128 v[144:147], v175
  ds_read_b128 v[148:151], v175 offset:4096
  v_add_u32 v171, 0x7100, v171
  v_add_u32 v175, 0x7100, v175
  v_mfma_f32_32x32x16_bf16 v[128:143], a[100:103], v[156:159], v[128:143]
  buffer_load_dwordx4 v10, s[16:19], s44 offen offset:0 lds
  buffer_load_dwordx4 v11, s[16:19], s44 offen offset:1024 lds
  s_waitcnt lgkmcnt(3)
  v_mfma_f32_4x4x4bf16_1k a[164:167], a[184:185], a[100:101], a[164:167]
  v_mfma_f32_4x4x4bf16_1k a[172:175], a[100:101], a[100:101], a[172:175]
  v_mfma_f32_4x4x4bf16_1k a[168:171], a[184:185], a[102:103], a[168:171]
  v_mfma_f32_4x4x4bf16_1k a[176:179], a[102:103], a[102:103], a[176:179]
  v_mfma_f32_32x32x16_bf16 v[112:127], a[104:107], v[160:163], v[112:127]
  buffer_load_dwordx4 v12, s[16:19], s44 offen offset:2048 lds
  v_mfma_f32_32x32x16_bf16 v[128:143], a[104:107], v[164:167], v[128:143]
  s_waitcnt vmcnt(14)
  s_barrier
  ds_read_b128 a[112:115], v168
  ds_read_b128 v[152:155], v172
  ds_read_b128 v[156:159], v172 offset:4096
  s_waitcnt lgkmcnt(3)
  s_add_u32 s45, s35, 2
  s_and_b32 s45, s45, 7
  s_mul_i32 s45, s45, 229376
  s_add_u32 s44, s38, s45
  s_add_u32 m0, s41, 28928
  v_mfma_f32_4x4x4bf16_1k a[164:167], a[184:185], a[104:105], a[164:167]
  v_mfma_f32_4x4x4bf16_1k a[172:175], a[104:105], a[104:105], a[172:175]
  v_mfma_f32_4x4x4bf16_1k a[168:171], a[184:185], a[106:107], a[168:171]
  v_mfma_f32_4x4x4bf16_1k a[176:179], a[106:107], a[106:107], a[176:179]
  v_mfma_f32_32x32x16_bf16 v[112:127], a[108:111], v[144:147], v[112:127]
  ds_read_b128 a[116:119], v169
  ds_read_b128 v[160:163], v173
  ds_read_b128 v[164:167], v173 offset:4096
  v_mfma_f32_32x32x16_bf16 v[128:143], a[108:111], v[148:151], v[128:143]
  buffer_load_dwordx4 v6, s[16:19], s44 offen offset:0 lds
  buffer_load_dwordx4 v7, s[16:19], s44 offen offset:1024 lds
  s_waitcnt lgkmcnt(3)
  v_mfma_f32_4x4x4bf16_1k a[164:167], a[184:185], a[108:109], a[164:167]
  v_mfma_f32_4x4x4bf16_1k a[172:175], a[108:109], a[108:109], a[172:175]
  v_mfma_f32_4x4x4bf16_1k a[168:171], a[184:185], a[110:111], a[168:171]
  v_mfma_f32_4x4x4bf16_1k a[176:179], a[110:111], a[110:111], a[176:179]
  v_mfma_f32_32x32x16_bf16 v[112:127], a[112:115], v[152:155], v[112:127]
  ds_read_b128 a[120:123], v170
  ds_read_b128 v[144:147], v174
  ds_read_b128 v[148:151], v174 offset:4096
  v_mfma_f32_32x32x16_bf16 v[128:143], a[112:115], v[156:159], v[128:143]
  buffer_load_dwordx4 v8, s[16:19], s44 offen offset:2048 lds
  buffer_load_dwordx4 v9, s[16:19], s44 offen offset:3072 lds
  s_waitcnt lgkmcnt(3)
  s_add_u32 m0, s41, 33024
  v_mfma_f32_16x16x32_bf16 a[156:159], a[180:183], v[152:155], a[156:159]
  v_mfma_f32_16x16x32_bf16 a[160:163], a[180:183], v[156:159], a[160:163]
  v_mfma_f32_4x4x4bf16_1k a[164:167], a[184:185], a[112:113], a[164:167]
  v_mfma_f32_4x4x4bf16_1k a[172:175], a[112:113], a[112:113], a[172:175]
  v_mfma_f32_4x4x4bf16_1k a[168:171], a[184:185], a[114:115], a[168:171]
  v_mfma_f32_4x4x4bf16_1k a[176:179], a[114:115], a[114:115], a[176:179]
  v_mfma_f32_32x32x16_bf16 v[112:127], a[116:119], v[160:163], v[112:127]
  ds_read_b128 a[124:127], v171
  ds_read_b128 v[152:155], v175
  ds_read_b128 v[156:159], v175 offset:4096
  v_mfma_f32_32x32x16_bf16 v[128:143], a[116:119], v[164:167], v[128:143]
  buffer_load_dwordx4 v10, s[16:19], s44 offen offset:0 lds
  buffer_load_dwordx4 v11, s[16:19], s44 offen offset:1024 lds
  ds_write_b32 v58, a156 offset:3584
  ds_write_b32 v58, a157 offset:3840
  ds_write_b32 v58, a160 offset:4096
  ds_write_b32 v58, a161 offset:4352
  s_waitcnt lgkmcnt(7)
  v_mfma_f32_4x4x4bf16_1k a[164:167], a[184:185], a[116:117], a[164:167]
  v_mfma_f32_4x4x4bf16_1k a[172:175], a[116:117], a[116:117], a[172:175]
  v_mfma_f32_4x4x4bf16_1k a[168:171], a[184:185], a[118:119], a[168:171]
  v_mfma_f32_4x4x4bf16_1k a[176:179], a[118:119], a[118:119], a[176:179]
  v_mfma_f32_32x32x16_bf16 v[112:127], a[120:123], v[144:147], v[112:127]
  buffer_load_dwordx4 v12, s[16:19], s44 offen offset:2048 lds
  v_mfma_f32_32x32x16_bf16 v[128:143], a[120:123], v[148:151], v[128:143]
  s_waitcnt lgkmcnt(0)
  s_waitcnt vmcnt(14)
  s_barrier
  ds_read_b64_tr_b16 a[200:201], v2 offset:0
  ds_read_b64_tr_b16 a[202:203], v2 offset:896
  ds_read_b64_tr_b16 a[204:205], v2 offset:32
  ds_read_b64_tr_b16 a[206:207], v2 offset:928
  ds_read_b64_tr_b16 a[208:209], v2 offset:64
  ds_read_b64_tr_b16 a[210:211], v2 offset:960
  ds_read_b64_tr_b16 a[212:213], v2 offset:96
  ds_read_b64_tr_b16 a[214:215], v2 offset:992
  s_add_u32 s45, s35, 3
  s_and_b32 s45, s45, 7
  s_mul_i32 s45, s45, 229376
  s_add_u32 s44, s38, s45
  s_add_u32 m0, s41, 71936
  v_mfma_f32_4x4x4bf16_1k a[164:167], a[184:185], a[120:121], a[164:167]
  v_mfma_f32_4x4x4bf16_1k a[172:175], a[120:121], a[120:121], a[172:175]
  v_mfma_f32_4x4x4bf16_1k a[168:171], a[184:185], a[122:123], a[168:171]
  v_mfma_f32_4x4x4bf16_1k a[176:179], a[122:123], a[122:123], a[176:179]
  v_mfma_f32_32x32x16_bf16 v[112:127], a[124:127], v[152:155], v[112:127]
  ds_read_b64_tr_b16 a[216:217], v2 offset:128
  ds_read_b64_tr_b16 a[218:219], v2 offset:1024
  ds_read_b64_tr_b16 a[220:221], v2 offset:160
  ds_read_b64_tr_b16 a[222:223], v2 offset:1056
  ds_read_b64_tr_b16 a[224:225], v2 offset:192
  ds_read_b64_tr_b16 a[226:227], v2 offset:1088
  v_add_u32 v2, 0xfffe0500, v2
  ds_read_b64_tr_b16 a[228:229], v3 offset:0
  ds_read_b64_tr_b16 a[230:231], v3 offset:896
  v_mfma_f32_32x32x16_bf16 v[128:143], a[124:127], v[156:159], v[128:143]
  buffer_load_dwordx4 v6, s[16:19], s44 offen offset:0 lds
  buffer_load_dwordx4 v7, s[16:19], s44 offen offset:1024 lds
  v_mfma_f32_4x4x4bf16_1k a[164:167], a[184:185], a[124:125], a[164:167]
  v_mfma_f32_4x4x4bf16_1k a[172:175], a[124:125], a[124:125], a[172:175]
  v_mfma_f32_4x4x4bf16_1k a[168:171], a[184:185], a[126:127], a[168:171]
  v_mfma_f32_4x4x4bf16_1k a[176:179], a[126:127], a[126:127], a[176:179]
  s_waitcnt lgkmcnt(8)
  v_mfma_f32_32x32x16_bf16 v[144:159], a[200:203], a[0:3], 0
  buffer_load_dwordx4 v8, s[16:19], s44 offen offset:2048 lds
  ds_read_b64_tr_b16 a[232:233], v3 offset:32
  ds_read_b64_tr_b16 a[234:235], v3 offset:928
  ds_read_b128 v[100:103], v59 offset:3584
  ds_read_b128 v[104:107], v59 offset:4096
  v_accvgpr_read_b32 v80, a172
  v_mfma_f32_16x16x32_bf16 a[128:131], a[180:183], a[200:203], 0
  v_mfma_f32_32x32x16_bf16 v[160:175], a[204:207], a[0:3], 0
  ds_read_b64_tr_b16 a[236:237], v3 offset:64
  ds_read_b64_tr_b16 a[238:239], v3 offset:960
  v_accvgpr_read_b32 v84, a176
  v_accvgpr_read_b32 v81, a173
  v_accvgpr_read_b32 v85, a177
  v_accvgpr_read_b32 v82, a174
  v_mfma_f32_16x16x32_bf16 a[132:135], a[180:183], a[204:207], 0
  v_mfma_f32_32x32x16_bf16 v[176:191], a[208:211], a[0:3], 0
  ds_read_b64_tr_b16 a[240:241], v3 offset:96
  ds_read_b64_tr_b16 a[242:243], v3 offset:992
  v_accvgpr_read_b32 v86, a178
  v_accvgpr_read_b32 v83, a175
  v_accvgpr_read_b32 v87, a179
  v_accvgpr_read_b32 v88, a164
  v_mfma_f32_16x16x32_bf16 a[136:139], a[180:183], a[208:211], 0
  v_mfma_f32_32x32x16_bf16 v[192:207], a[212:215], a[0:3], 0
  buffer_load_dwordx4 v9, s[16:19], s44 offen offset:3072 lds
  ds_read_b64_tr_b16 a[244:245], v3 offset:128
  ds_read_b64_tr_b16 a[246:247], v3 offset:1024
  s_waitcnt lgkmcnt(10)
  v_accvgpr_read_b32 v89, a168
  v_add_f32 v80, v80, v84
  v_mfma_f32_16x16x32_bf16 a[140:143], a[180:183], a[212:215], 0
  v_mfma_f32_32x32x16_bf16 v[208:223], a[216:219], a[0:3], 0
  ds_read_b64_tr_b16 a[200:201], v3 offset:160
  ds_read_b64_tr_b16 a[202:203], v3 offset:1056
  v_add_f32 v81, v81, v85
  v_add_f32 v82, v82, v86
  v_add_f32 v83, v83, v87
  v_and_b32 v90, 3, v1
  v_mfma_f32_16x16x32_bf16 a[144:147], a[180:183], a[216:219], 0
  v_mfma_f32_32x32x16_bf16 v[224:239], a[220:223], a[0:3], 0
  ds_read_b64_tr_b16 a[204:205], v3 offset:192
  ds_read_b64_tr_b16 a[206:207], v3 offset:1088
  v_add_u32 v3, 0xfffe0500, v3
  v_add_f32_e64 v88, v88, v89
  v_cmp_eq_u32 s[88:89], 1, v90
  v_cmp_eq_u32 s[90:91], 2, v90
  v_mfma_f32_16x16x32_bf16 a[148:151], a[180:183], a[220:223], 0
  v_mfma_f32_32x32x16_bf16 v[240:255], a[224:227], a[0:3], 0
  s_add_u32 m0, s41, 76032
  s_nop 0
  buffer_load_dwordx4 v10, s[16:19], s44 offen offset:0 lds
  ds_read_b64_tr_b16 a[208:209], v4 offset:0
  ds_read_b64_tr_b16 a[210:211], v4 offset:896
  v_cmp_eq_u32 vcc, 3, v90
  v_mov_b32_e64 v89, v88
  v_mfma_f32_16x16x32_bf16 a[152:155], a[180:183], a[224:227], 0
  v_mfma_f32_32x32x16_bf16 v[144:159], a[228:231], a[4:7], v[144:159]
  ds_read_b64_tr_b16 a[212:213], v4 offset:32
  ds_read_b64_tr_b16 a[214:215], v4 offset:928
  s_waitcnt lgkmcnt(8)
  v_cndmask_b32 v80, v80, v81, s[88:89]
  v_permlane32_swap_b32 v88, v89
  v_cndmask_b32 v80, v80, v82, s[90:91]
  v_mov_b32 v82, 0x3b000000
  v_cndmask_b32_e64 v80, v80, v83, vcc
  v_mfma_f32_32x32x16_bf16 v[160:175], a[232:235], a[4:7], v[160:175]
  ds_read_b64_tr_b16 a[216:217], v4 offset:64
  ds_read_b64_tr_b16 a[218:219], v4 offset:960
  v_add_f32 v88, v88, v89
  v_mov_b32 v81, v80
  v_mul_f32_e64 v88, v88, v82
  v_cmp_gt_u32 vcc, 32, v1
  v_permlane32_swap_b32 v80, v81
  v_cvt_pk_bf16_f32 v56, v88, v88
  v_mfma_f32_32x32x16_bf16 v[176:191], a[236:239], a[4:7], v[176:191]
  buffer_load_dwordx4 v11, s[16:19], s44 offen offset:1024 lds
  ds_read_b64_tr_b16 a[220:221], v4 offset:96
  ds_read_b64_tr_b16 a[222:223], v4 offset:992
  v_add_f32_e64 v80, v80, v81
  v_xor_b32 v83, 0x80008000, v56
  v_mul_f32 v80, v80, v82
  v_cndmask_b32 v60, 0, v83, vcc
  v_fma_f32 v80, -v88, v88, v80
  v_mfma_f32_32x32x16_bf16 v[192:207], a[240:243], a[4:7], v[192:207]
  ds_read_b64_tr_b16 a[224:225], v4 offset:128
  ds_read_b64_tr_b16 a[226:227], v4 offset:1024
  v_lshlrev_b32 v56, 16, v56
  v_max_f32 v80, 0, v80
  v_add_f32 v100, v100, v101
  v_add_f32 v102, v102, v103
  v_add_f32_e64 v100, v100, v102
  v_cvt_pk_bf16_f32 v101, v100, v100
  v_mfma_f32_32x32x16_bf16 v[208:223], a[244:247], a[4:7], v[208:223]
  ds_read_b64_tr_b16 a[228:229], v4 offset:160
  ds_read_b64_tr_b16 a[230:231], v4 offset:1056
  s_waitcnt lgkmcnt(8)
  v_lshlrev_b32 v101, 16, v101
  v_sub_f32_e64 v102, v100, v101
  v_cvt_pk_bf16_f32 v64, v101, v102
  v_cvt_pk_bf16_f32 v80, v80, v80
  v_lshlrev_b32_e64 v80, 16, v80
  v_mfma_f32_32x32x16_bf16 v[224:239], a[200:203], a[4:7], v[224:239]
  buffer_load_dwordx4 v12, s[16:19], s44 offen offset:2048 lds
  ds_read_b64_tr_b16 a[232:233], v4 offset:192
  ds_read_b64_tr_b16 a[234:235], v4 offset:1088
  v_add_u32 v4, 0xfffe0500, v4
  v_mfma_f32_32x32x16_bf16 v[112:127], v[60:63], v[64:67], v[112:127]
  v_add_f32 v80, 0x3727c5ac, v80
  v_cvt_pk_bf16_f32 v80, v80, v80
  v_lshlrev_b32_e64 v80, 16, v80
  v_mfma_f32_32x32x16_bf16 v[240:255], a[204:207], a[4:7], v[240:255]
  ds_read_b64_tr_b16 a[236:237], v5 offset:0
  ds_read_b64_tr_b16 a[238:239], v5 offset:896
  v_sqrt_f32 v80, v80
  v_add_f32 v104, v104, v105
  v_add_f32 v106, v106, v107
  v_add_f32 v104, v104, v106
  v_cvt_pk_bf16_f32 v105, v104, v104
  v_mfma_f32_32x32x16_bf16 v[144:159], a[208:211], a[8:11], v[144:159]
  ds_read_b64_tr_b16 a[240:241], v5 offset:32
  ds_read_b64_tr_b16 a[242:243], v5 offset:928
  v_lshlrev_b32 v105, 16, v105
  v_sub_f32 v106, v104, v105
  v_cvt_pk_bf16_f32 v64, v105, v106
  v_cvt_pk_bf16_f32 v80, v80, v80
  v_lshlrev_b32_e64 v80, 16, v80
  v_mfma_f32_32x32x16_bf16 v[128:143], v[60:63], v[64:67], v[128:143]
  v_mfma_f32_32x32x16_bf16 v[160:175], a[212:215], a[8:11], v[160:175]
  ds_read_b64_tr_b16 a[244:245], v5 offset:64
  ds_read_b64_tr_b16 a[246:247], v5 offset:960
  s_waitcnt lgkmcnt(8)
  v_rcp_f32 v57, v80
  v_mul_f32 v55, v80, v80
  v_mov_b32 v96, 0
  ds_write_b32 v76, v57
  v_mfma_f32_32x32x16_bf16 v[176:191], a[216:219], a[8:11], v[176:191]
  ds_read_b64_tr_b16 a[200:201], v5 offset:96
  ds_read_b64_tr_b16 a[202:203], v5 offset:992
  ds_read_b128 v[80:83], v77 offset:0
  ds_read_b128 v[84:87], v77 offset:16
  ds_read_b128 v[88:91], v77 offset:32
  ds_read_b128 v[92:95], v77 offset:48
  v_mul_f32 v54, 0xbfb8aa3b, v57
  buffer_store_dwordx2 v[56:57], v75, s[20:23], 0 offen sc1
  v_mfma_f32_32x32x16_bf16 v[192:207], a[220:223], a[8:11], v[192:207]
  ds_read_b64_tr_b16 a[204:205], v5 offset:128
  ds_read_b64_tr_b16 a[206:207], v5 offset:1024
  buffer_load_dword v78, v96, s[24:27], 0 offen sc1
  v_mfma_f32_32x32x16_bf16 v[208:223], a[224:227], a[8:11], v[208:223]
  ds_read_b64_tr_b16 a[208:209], v5 offset:160
  ds_read_b64_tr_b16 a[210:211], v5 offset:1056
  v_mfma_f32_32x32x16_bf16 v[224:239], a[228:231], a[8:11], v[224:239]
  ds_read_b64_tr_b16 a[212:213], v5 offset:192
  ds_read_b64_tr_b16 a[214:215], v5 offset:1088
  v_add_u32 v5, 0xfffe0500, v5
  s_waitcnt lgkmcnt(13)
  s_waitcnt lgkmcnt(9)
  v_mul_f32 v112, v112, v80
  v_mul_f32 v128, v128, v80
  v_mul_f32 v113, v113, v81
  v_mul_f32 v129, v129, v81
  v_mfma_f32_32x32x16_bf16 v[240:255], a[232:235], a[8:11], v[240:255]
  s_waitcnt vmcnt(16)
  s_barrier
  ds_read_b64_tr_b16 a[216:217], v2 offset:0
  ds_read_b64_tr_b16 a[218:219], v2 offset:896
  v_mul_f32 v114, v114, v82
  v_mul_f32 v130, v130, v82
  v_mul_f32 v115, v115, v83
  v_mul_f32 v131, v131, v83
  v_mfma_f32_32x32x16_bf16 v[144:159], a[236:239], a[12:15], v[144:159]
  s_add_u32 s45, s35, 4
  s_and_b32 s45, s45, 7
  s_mul_i32 s45, s45, 229376
  s_add_u32 s44, s38, s45
  s_add_u32 m0, s41, 100864
  s_nop 0
  buffer_load_dwordx4 v6, s[16:19], s44 offen offset:0 lds
  ds_read_b64_tr_b16 a[220:221], v2 offset:32
  ds_read_b64_tr_b16 a[222:223], v2 offset:928
  v_mfma_f32_32x32x16_bf16 v[160:175], a[240:243], a[12:15], v[160:175]
  ds_read_b64_tr_b16 a[224:225], v2 offset:64
  ds_read_b64_tr_b16 a[226:227], v2 offset:960
  s_waitcnt lgkmcnt(14)
  v_mul_f32 v116, v116, v84
  v_mul_f32 v132, v132, v84
  v_mul_f32 v117, v117, v85
  v_mul_f32 v133, v133, v85
  v_mul_f32 v118, v118, v86
  v_mul_f32_e64 v134, v134, v86
  v_mfma_f32_32x32x16_bf16 v[176:191], a[244:247], a[12:15], v[176:191]
  ds_read_b64_tr_b16 a[228:229], v2 offset:96
  ds_read_b64_tr_b16 a[230:231], v2 offset:992
  s_waitcnt lgkmcnt(8)
  v_mul_f32 v119, v119, v87
  v_mul_f32 v135, v135, v87
  v_mul_f32 v120, v120, v88
  v_mul_f32 v136, v136, v88
  v_mul_f32 v121, v121, v89
  v_mfma_f32_32x32x16_bf16 v[192:207], a[200:203], a[12:15], v[192:207]
  buffer_load_dwordx4 v7, s[16:19], s44 offen offset:1024 lds
  ds_read_b64_tr_b16 a[232:233], v2 offset:128
  ds_read_b64_tr_b16 a[234:235], v2 offset:1024
  v_mul_f32 v137, v137, v89
  v_mul_f32 v122, v122, v90
  v_mul_f32 v138, v138, v90
  v_mul_f32 v123, v123, v91
  v_mul_f32_e64 v139, v139, v91
  v_mfma_f32_32x32x16_bf16 v[208:223], a[204:207], a[12:15], v[208:223]
  ds_read_b64_tr_b16 a[236:237], v2 offset:160
  ds_read_b64_tr_b16 a[238:239], v2 offset:1056
  v_mul_f32 v124, v124, v92
  v_mul_f32 v140, v140, v92
  v_mul_f32 v125, v125, v93
  v_mul_f32 v141, v141, v93
  v_mul_f32 v126, v126, v94
  v_mul_f32 v142, v142, v94
  v_mfma_f32_32x32x16_bf16 v[224:239], a[208:211], a[12:15], v[224:239]
  ds_read_b64_tr_b16 a[240:241], v2 offset:192
  ds_read_b64_tr_b16 a[242:243], v2 offset:1088
  v_add_u32 v2, 0x7100, v2
  v_mul_f32 v127, v127, v95
  v_mul_f32 v143, v143, v95
  v_fma_f32 v80, v40, v112, v113
  v_fma_f32 v81, v40, v128, v129
  v_fma_f32 v80, -v41, v128, v80
  v_mfma_f32_32x32x16_bf16 v[240:255], a[212:215], a[12:15], v[240:255]
  buffer_load_dwordx4 v8, s[16:19], s44 offen offset:2048 lds
  ds_read_b64_tr_b16 a[244:245], v3 offset:0
  ds_read_b64_tr_b16 a[246:247], v3 offset:896
  s_waitcnt lgkmcnt(8)
  v_fma_f32 v81, v41, v112, v81
  v_fma_f32 v82, v40, v80, v114
  v_fma_f32 v83, v40, v81, v130
  v_fma_f32 v82, -v41, v81, v82
  v_mfma_f32_32x32x16_bf16 v[144:159], a[216:219], a[16:19], v[144:159]
  ds_read_b64_tr_b16 a[200:201], v3 offset:32
  ds_read_b64_tr_b16 a[202:203], v3 offset:928
  s_lshr_b32 s98, s2, 3
  s_lshl_b32 s98, s98, 2
  s_add_u32 s98, s98, s32
  s_lshl_b32 s99, s98, 12
  v_add_u32 v79, s99, v15
  global_load_dwordx4 a[188:191], v79, s[62:63] offset:0
  v_mfma_f32_16x16x32_bf16 a[128:131], a[180:183], a[216:219], a[128:131]
  v_mfma_f32_32x32x16_bf16 v[160:175], a[220:223], a[16:19], v[160:175]
  ds_read_b64_tr_b16 a[204:205], v3 offset:64
  ds_read_b64_tr_b16 a[206:207], v3 offset:960
  v_fma_f32 v83, v41, v80, v83
  v_fma_f32 v80, v40, v82, v115
  v_fma_f32 v81, v40, v83, v131
  v_fma_f32 v80, -v41, v83, v80
  v_mfma_f32_16x16x32_bf16 a[132:135], a[180:183], a[220:223], a[132:135]
  v_mfma_f32_32x32x16_bf16 v[176:191], a[224:227], a[16:19], v[176:191]
  buffer_load_dwordx4 v9, s[16:19], s44 offen offset:3072 lds
  ds_read_b64_tr_b16 a[208:209], v3 offset:96
  ds_read_b64_tr_b16 a[210:211], v3 offset:992
  v_fma_f32 v81, v41, v82, v81
  v_fma_f32 v82, v40, v80, v116
  v_fma_f32 v83, v40, v81, v132
  v_mfma_f32_16x16x32_bf16 a[136:139], a[180:183], a[224:227], a[136:139]
  v_mfma_f32_32x32x16_bf16 v[192:207], a[228:231], a[16:19], v[192:207]
  ds_read_b64_tr_b16 a[212:213], v3 offset:128
  ds_read_b64_tr_b16 a[214:215], v3 offset:1024
  global_load_dwordx4 a[188:191], v79, s[62:63] offset:1024
  s_waitcnt lgkmcnt(8)
  v_fma_f32 v82, -v41, v81, v82
  v_fma_f32 v83, v41, v80, v83
  v_mfma_f32_16x16x32_bf16 a[140:143], a[180:183], a[228:231], a[140:143]
  v_mfma_f32_32x32x16_bf16 v[208:223], a[232:235], a[16:19], v[208:223]
  ds_read_b64_tr_b16 a[216:217], v3 offset:160
  ds_read_b64_tr_b16 a[218:219], v3 offset:1056
  v_fma_f32 v80, v40, v82, v117
  v_fma_f32 v81, v40, v83, v133
  v_fma_f32 v80, -v41, v83, v80
  v_fma_f32 v81, v41, v82, v81
  v_mfma_f32_16x16x32_bf16 a[144:147], a[180:183], a[232:235], a[144:147]
  v_mfma_f32_32x32x16_bf16 v[224:239], a[236:239], a[16:19], v[224:239]
  s_add_u32 m0, s41, 104960
  s_nop 0
  buffer_load_dwordx4 v10, s[16:19], s44 offen offset:0 lds
  ds_read_b64_tr_b16 a[220:221], v3 offset:192
  ds_read_b64_tr_b16 a[222:223], v3 offset:1088
  v_add_u32 v3, 0x7100, v3
  v_fma_f32 v82, v40, v80, v118
  v_mfma_f32_16x16x32_bf16 a[148:151], a[180:183], a[236:239], a[148:151]
  v_mfma_f32_32x32x16_bf16 v[240:255], a[240:243], a[16:19], v[240:255]
  ds_read_b64_tr_b16 a[224:225], v4 offset:0
  ds_read_b64_tr_b16 a[226:227], v4 offset:896
  global_load_dwordx4 a[188:191], v79, s[62:63] offset:2048
  v_fma_f32 v83, v40, v81, v134
  v_fma_f32 v82, -v41, v81, v82
  v_fma_f32 v83, v41, v80, v83
  v_mfma_f32_16x16x32_bf16 a[152:155], a[180:183], a[240:243], a[152:155]
  v_mfma_f32_32x32x16_bf16 v[144:159], a[244:247], a[20:23], v[144:159]
  ds_read_b64_tr_b16 a[228:229], v4 offset:32
  ds_read_b64_tr_b16 a[230:231], v4 offset:928
  s_waitcnt lgkmcnt(8)
  v_fma_f32 v80, v40, v82, v119
  v_fma_f32 v81, v40, v83, v135
  v_fma_f32 v80, -v41, v83, v80
  v_fma_f32 v81, v41, v82, v81
  v_fma_f32 v82, v40, v80, v120
  v_mfma_f32_32x32x16_bf16 v[160:175], a[200:203], a[20:23], v[160:175]
  buffer_load_dwordx4 v11, s[16:19], s44 offen offset:1024 lds
  ds_read_b64_tr_b16 a[232:233], v4 offset:64
  ds_read_b64_tr_b16 a[234:235], v4 offset:960
  v_fma_f32 v83, v40, v81, v136
  v_fma_f32 v82, -v41, v81, v82
  v_fma_f32 v83, v41, v80, v83
  v_fma_f32 v80, v40, v82, v121
  v_fma_f32 v81, v40, v83, v137
  v_mfma_f32_32x32x16_bf16 v[176:191], a[204:207], a[20:23], v[176:191]
  ds_read_b64_tr_b16 a[236:237], v4 offset:96
  ds_read_b64_tr_b16 a[238:239], v4 offset:992
  global_load_dwordx4 a[188:191], v79, s[62:63] offset:3072
  v_fma_f32 v80, -v41, v83, v80
  v_fma_f32 v81, v41, v82, v81
  v_fma_f32 v82, v40, v80, v122
  v_fma_f32 v83, v40, v81, v138
  v_fma_f32 v82, -v41, v81, v82
  v_mfma_f32_32x32x16_bf16 v[192:207], a[208:211], a[20:23], v[192:207]
  ds_read_b64_tr_b16 a[240:241], v4 offset:128
  ds_read_b64_tr_b16 a[242:243], v4 offset:1024
  v_fma_f32 v83, v41, v80, v83
  v_fma_f32 v80, v40, v82, v123
  v_fma_f32 v81, v40, v83, v139
  v_fma_f32 v80, -v41, v83, v80
  v_fma_f32 v81, v41, v82, v81
  v_fma_f32 v82, v40, v80, v124
  v_mfma_f32_32x32x16_bf16 v[208:223], a[212:215], a[20:23], v[208:223]
  buffer_load_dwordx4 v12, s[16:19], s44 offen offset:2048 lds
  ds_read_b64_tr_b16 a[244:245], v4 offset:160
  ds_read_b64_tr_b16 a[246:247], v4 offset:1056
  s_waitcnt lgkmcnt(8)
  v_fma_f32 v83, v40, v81, v140
  v_fma_f32 v82, -v41, v81, v82
  v_fma_f32 v83, v41, v80, v83
  v_fma_f32 v80, v40, v82, v125
  v_mfma_f32_32x32x16_bf16 v[224:239], a[216:219], a[20:23], v[224:239]
  ds_read_b64_tr_b16 a[200:201], v4 offset:192
  ds_read_b64_tr_b16 a[202:203], v4 offset:1088
  v_add_u32 v4, 0x7100, v4
  global_load_dwordx4 a[188:191], v79, s[64:65] offset:0
  v_fma_f32 v81, v40, v83, v141
  v_fma_f32 v80, -v41, v83, v80
  v_fma_f32 v81, v41, v82, v81
  v_fma_f32 v82, v40, v80, v126
  v_mfma_f32_32x32x16_bf16 v[240:255], a[220:223], a[20:23], v[240:255]
  ds_read_b64_tr_b16 a[204:205], v5 offset:0
  ds_read_b64_tr_b16 a[206:207], v5 offset:896
  v_fma_f32 v83, v40, v81, v142
  v_fma_f32 v82, -v41, v81, v82
  v_fma_f32 v83, v41, v80, v83
  v_fma_f32 v80, v40, v82, v127
  v_fma_f32 v81, v40, v83, v143
  v_fma_f32 v80, -v41, v83, v80
  v_mfma_f32_32x32x16_bf16 v[144:159], a[224:227], a[24:27], v[144:159]
  ds_read_b64_tr_b16 a[208:209], v5 offset:32
  ds_read_b64_tr_b16 a[210:211], v5 offset:928
  v_fma_f32 v81, v41, v82, v81
  ds_write_b64 v68, v[80:81]
  v_mfma_f32_32x32x16_bf16 v[160:175], a[228:231], a[24:27], v[160:175]
  ds_read_b64_tr_b16 a[212:213], v5 offset:64
  ds_read_b64_tr_b16 a[214:215], v5 offset:960
  global_load_dwordx4 a[188:191], v79, s[64:65] offset:1024
  s_waitcnt lgkmcnt(9)
  v_mfma_f32_32x32x16_bf16 v[176:191], a[232:235], a[24:27], v[176:191]
  ds_read_b64_tr_b16 a[216:217], v5 offset:96
  ds_read_b64_tr_b16 a[218:219], v5 offset:992
  v_mfma_f32_32x32x16_bf16 v[192:207], a[236:239], a[24:27], v[192:207]
  ds_read_b64_tr_b16 a[220:221], v5 offset:128
  ds_read_b64_tr_b16 a[222:223], v5 offset:1024
  s_waitcnt lgkmcnt(6)
  s_barrier
  ds_read_b64 v[84:85], v69 offset:0
  ds_read_b64 v[86:87], v69 offset:256
  ds_read_b64 v[88:89], v69 offset:512
  ds_read_b64 v[90:91], v69 offset:768
  v_mfma_f32_32x32x16_bf16 v[208:223], a[240:243], a[24:27], v[208:223]
  ds_read_b64_tr_b16 a[224:225], v5 offset:160
  ds_read_b64_tr_b16 a[226:227], v5 offset:1056
  ds_read_b64 v[92:93], v69 offset:1024
  ds_read_b64 v[94:95], v69 offset:1280
  ds_read_b64 v[96:97], v69 offset:1536
  ds_read_b64 v[98:99], v69 offset:1792
  s_waitcnt vmcnt(13)
  v_readfirstlane_b32 s50, v78
  v_mov_b32 v100, 0
  v_mfma_f32_32x32x16_bf16 v[224:239], a[244:247], a[24:27], v[224:239]
  ds_read_b64_tr_b16 a[228:229], v5 offset:192
  ds_read_b64_tr_b16 a[230:231], v5 offset:1088
  v_add_u32 v5, 0x7100, v5
  s_waitcnt lgkmcnt(15)
  v_mov_b32_e64 v101, 0
  s_cmp_eq_u32 s50, 0
  s_cbranch_scc1 K1_EPSPIN
K1_EPBACK:
  v_mfma_f32_32x32x16_bf16 v[240:255], a[200:203], a[24:27], v[240:255]
  s_barrier
  ds_read_b64_tr_b16 a[232:233], v2 offset:0
  ds_read_b64_tr_b16 a[234:235], v2 offset:896
  v_mfma_f32_32x32x16_bf16 v[144:159], a[204:207], a[28:31], v[144:159]
  ds_read_b64_tr_b16 a[236:237], v2 offset:32
  ds_read_b64_tr_b16 a[238:239], v2 offset:928
  v_cmp_eq_u32 vcc, 1, v14
  s_waitcnt lgkmcnt(14)
  v_fma_f32 v82, v46, v84, v86
  v_fma_f32 v83, v46, v85, v87
  v_fma_f32 v82, -v47, v85, v82
  v_fma_f32 v83, v47, v84, v83
  v_cndmask_b32_e64 v100, v100, v84, vcc
  v_mfma_f32_32x32x16_bf16 v[160:175], a[208:211], a[28:31], v[160:175]
  ds_read_b64_tr_b16 a[240:241], v2 offset:64
  ds_read_b64_tr_b16 a[242:243], v2 offset:960
  v_cndmask_b32_e64 v101, v101, v85, vcc
  v_cmp_eq_u32 vcc, 2, v14
  s_waitcnt lgkmcnt(15)
  v_fma_f32 v80, v46, v82, v88
  v_fma_f32 v81, v46, v83, v89
  v_fma_f32 v80, -v47, v83, v80
  v_fma_f32 v81, v47, v82, v81
  v_mfma_f32_32x32x16_bf16 v[176:191], a[212:215], a[28:31], v[176:191]
  s_add_u32 s45, s35, 5
  s_and_b32 s45, s45, 7
  s_mul_i32 s45, s45, 229376
  s_add_u32 s44, s38, s45
  s_add_u32 m0, s41, 129792
  s_nop 0
  buffer_load_dwordx4 v6, s[16:19], s44 offen offset:0 lds
  ds_read_b64_tr_b16 a[244:245], v2 offset:96
  ds_read_b64_tr_b16 a[246:247], v2 offset:992
  s_waitcnt lgkmcnt(8)
  v_mfma_f32_32x32x16_bf16 v[192:207], a[216:219], a[28:31], v[192:207]
  ds_read_b64_tr_b16 a[200:201], v2 offset:128
  ds_read_b64_tr_b16 a[202:203], v2 offset:1024
  v_cndmask_b32 v100, v100, v82, vcc
  v_cndmask_b32 v101, v101, v83, vcc
  v_cmp_eq_u32 vcc, 3, v14
  v_fma_f32 v82, v46, v80, v90
  v_fma_f32 v83, v46, v81, v91
  v_fma_f32 v82, -v47, v81, v82
  v_mfma_f32_32x32x16_bf16 v[208:223], a[220:223], a[28:31], v[208:223]
  ds_read_b64_tr_b16 a[204:205], v2 offset:160
  ds_read_b64_tr_b16 a[206:207], v2 offset:1056
  v_fma_f32 v83, v47, v80, v83
  v_cndmask_b32 v100, v100, v80, vcc
  v_cndmask_b32 v101, v101, v81, vcc
  v_cmp_eq_u32_e64 vcc, 4, v14
  v_fma_f32 v80, v46, v82, v92
  v_fma_f32 v81, v46, v83, v93
  v_mfma_f32_32x32x16_bf16 v[224:239], a[224:227], a[28:31], v[224:239]
  buffer_load_dwordx4 v7, s[16:19], s44 offen offset:1024 lds
  ds_read_b64_tr_b16 a[208:209], v2 offset:192
  ds_read_b64_tr_b16 a[210:211], v2 offset:1088
  v_add_u32 v2, 0xa800, v2
  v_fma_f32 v80, -v47, v83, v80
  v_fma_f32 v81, v47, v82, v81
  v_cndmask_b32 v100, v100, v82, vcc
  v_cndmask_b32 v101, v101, v83, vcc
  v_mfma_f32_32x32x16_bf16 v[240:255], a[228:231], a[28:31], v[240:255]
  ds_read_b64_tr_b16 a[212:213], v3 offset:0
  ds_read_b64_tr_b16 a[214:215], v3 offset:896
  s_waitcnt lgkmcnt(8)
  v_cmp_eq_u32 vcc, 5, v14
  v_fma_f32 v82, v46, v80, v94
  v_fma_f32 v83, v46, v81, v95
  v_fma_f32 v82, -v47, v81, v82
  v_fma_f32 v83, v47, v80, v83
  v_mfma_f32_32x32x16_bf16 v[144:159], a[232:235], a[32:35], v[144:159]
  ds_read_b64_tr_b16 a[216:217], v3 offset:32
  ds_read_b64_tr_b16 a[218:219], v3 offset:928
  global_load_dwordx4 a[188:191], v79, s[64:65] offset:2048
  v_cndmask_b32 v100, v100, v80, vcc
  v_cndmask_b32 v101, v101, v81, vcc
  v_cmp_eq_u32_e64 vcc, 6, v14
  v_mfma_f32_16x16x32_bf16 a[128:131], a[180:183], a[232:235], a[128:131]
  v_mfma_f32_32x32x16_bf16 v[160:175], a[236:239], a[32:35], v[160:175]
  buffer_load_dwordx4 v8, s[16:19], s44 offen offset:2048 lds
  ds_read_b64_tr_b16 a[220:221], v3 offset:64
  ds_read_b64_tr_b16 a[222:223], v3 offset:960
  v_fma_f32 v80, v46, v82, v96
  v_fma_f32 v81, v46, v83, v97
  v_fma_f32 v80, -v47, v83, v80
  v_mfma_f32_16x16x32_bf16 a[132:135], a[180:183], a[236:239], a[132:135]
  v_mfma_f32_32x32x16_bf16 v[176:191], a[240:243], a[32:35], v[176:191]
  ds_read_b64_tr_b16 a[224:225], v3 offset:96
  ds_read_b64_tr_b16 a[226:227], v3 offset:992
  v_fma_f32 v81, v47, v82, v81
  v_cndmask_b32 v100, v100, v82, vcc
  v_cndmask_b32 v101, v101, v83, vcc
  v_cmp_eq_u32 vcc, 7, v14
  v_mfma_f32_16x16x32_bf16 a[136:139], a[180:183], a[240:243], a[136:139]
  v_mfma_f32_32x32x16_bf16 v[192:207], a[244:247], a[32:35], v[192:207]
  ds_read_b64_tr_b16 a[228:229], v3 offset:128
  ds_read_b64_tr_b16 a[230:231], v3 offset:1024
  global_load_dwordx4 a[188:191], v79, s[64:65] offset:3072
  s_waitcnt lgkmcnt(8)
  v_fma_f32 v82, v46, v80, v98
  v_fma_f32 v83, v46, v81, v99
  v_mfma_f32_16x16x32_bf16 a[140:143], a[180:183], a[244:247], a[140:143]
  v_mfma_f32_32x32x16_bf16 v[208:223], a[200:203], a[32:35], v[208:223]
  buffer_load_dwordx4 v9, s[16:19], s44 offen offset:3072 lds
  ds_read_b64_tr_b16 a[232:233], v3 offset:160
  ds_read_b64_tr_b16 a[234:235], v3 offset:1056
  v_fma_f32 v82, -v47, v81, v82
  v_fma_f32 v83, v47, v80, v83
  v_cndmask_b32_e64 v100, v100, v80, vcc
  v_mfma_f32_16x16x32_bf16 a[144:147], a[180:183], a[200:203], a[144:147]
  v_mfma_f32_32x32x16_bf16 v[224:239], a[204:207], a[32:35], v[224:239]
  ds_read_b64_tr_b16 a[236:237], v3 offset:192
  ds_read_b64_tr_b16 a[238:239], v3 offset:1088
  v_add_u32 v3, 0xa800, v3
  v_cndmask_b32 v101, v101, v81, vcc
  v_mov_b32 v84, v82
  v_mov_b32_e64 v85, s50
  v_mfma_f32_16x16x32_bf16 a[148:151], a[180:183], a[204:207], a[148:151]
  v_mfma_f32_32x32x16_bf16 v[240:255], a[208:211], a[32:35], v[240:255]
  ds_read_b64_tr_b16 a[240:241], v4 offset:0
  ds_read_b64_tr_b16 a[242:243], v4 offset:896
  s_mul_i32 s99, s98, 14336
  v_add_u32_e64 v79, s99, v15
  global_load_dwordx4 a[188:191], v79, s[76:77] offset:0
  v_mfma_f32_16x16x32_bf16 a[152:155], a[180:183], a[208:211], a[152:155]
  v_mfma_f32_32x32x16_bf16 v[144:159], a[212:215], a[36:39], v[144:159]
  s_add_u32 m0, s41, 133888
  s_nop 0
  buffer_load_dwordx4 v10, s[16:19], s44 offen offset:0 lds
  ds_read_b64_tr_b16 a[244:245], v4 offset:32
  ds_read_b64_tr_b16 a[246:247], v4 offset:928
  s_waitcnt lgkmcnt(8)
  v_mov_b32 v86, v83
  v_mov_b32 v87, s50
  v_mfma_f32_32x32x16_bf16 v[160:175], a[216:219], a[36:39], v[160:175]
  ds_read_b64_tr_b16 a[200:201], v4 offset:64
  ds_read_b64_tr_b16 a[202:203], v4 offset:960
  buffer_store_dwordx4 v[84:87], v70, s[20:23], 0 offen sc1
  v_lshrrev_b32 v34, 4, v1
  v_and_b32 v35, 1, v34
  v_lshrrev_b32_e64 v34, 1, v34
  v_bfe_u32 v36, v1, 2, 2
  v_mfma_f32_32x32x16_bf16 v[176:191], a[220:223], a[36:39], v[176:191]
  ds_read_b64_tr_b16 a[204:205], v4 offset:96
  ds_read_b64_tr_b16 a[206:207], v4 offset:992
  global_load_dwordx4 a[188:191], v79, s[76:77] offset:1024
  v_lshl_add_u32 v34, v34, 3, v36
  v_mul_u32_u24 v34, 80, v34
  v_and_b32_e64 v36, 1, v1
  v_bfe_u32 v37, v1, 1, 1
  v_mfma_f32_32x32x16_bf16 v[192:207], a[224:227], a[36:39], v[192:207]
  buffer_load_dwordx4 v11, s[16:19], s44 offen offset:1024 lds
  ds_read_b64_tr_b16 a[208:209], v4 offset:128
  ds_read_b64_tr_b16 a[210:211], v4 offset:1024
  v_lshlrev_b32_e64 v36, 5, v36
  v_lshl_add_u32 v36, v35, 4, v36
  v_lshl_add_u32 v36, v37, 3, v36
  s_mul_i32 s6, s32, 5120
  v_mfma_f32_32x32x16_bf16 v[208:223], a[228:231], a[36:39], v[208:223]
  ds_read_b64_tr_b16 a[212:213], v4 offset:160
  ds_read_b64_tr_b16 a[214:215], v4 offset:1056
  s_waitcnt lgkmcnt(8)
  s_add_u32 s6, s6, 71936
  v_add3_u32 v74, v34, v36, s6
  v_lshrrev_b32 v35, 5, v1
  v_mul_u32_u24 v34, 80, v13
  v_mfma_f32_32x32x16_bf16 v[224:239], a[232:235], a[36:39], v[224:239]
  ds_read_b64_tr_b16 a[216:217], v4 offset:192
  ds_read_b64_tr_b16 a[218:219], v4 offset:1088
  v_add_u32 v4, 0xa800, v4
  global_load_dwordx4 a[188:191], v79, s[76:77] offset:2048
  v_lshl_add_u32 v34, v35, 5, v34
  v_add_u32 v73, s6, v34
  s_lshl_b32 s6, s34, 9
  v_mfma_f32_32x32x16_bf16 v[240:255], a[236:239], a[36:39], v[240:255]
  buffer_load_dwordx4 v12, s[16:19], s44 offen offset:2048 lds
  ds_read_b64_tr_b16 a[220:221], v5 offset:0
  ds_read_b64_tr_b16 a[222:223], v5 offset:896
  s_add_u32 s6, s6, 4096
  v_lshlrev_b32_e64 v34, 13, v14
  v_lshl_add_u32 v34, v13, 4, v34
  v_add_u32_e64 v71, s6, v34
  v_mfma_f32_32x32x16_bf16 v[144:159], a[240:243], a[40:43], v[144:159]
  ds_read_b64_tr_b16 a[224:225], v5 offset:32
  ds_read_b64_tr_b16 a[226:227], v5 offset:928
  v_add_u32_e64 v35, 8, v14
  v_add_u32 v72, 0x10000, v71
  v_cmp_gt_u32 s[84:85], s33, v14
  v_cmp_gt_u32 s[86:87], s33, v35
  v_cvt_f32_u32_e64 v34, v14
  v_mfma_f32_32x32x16_bf16 v[160:175], a[244:247], a[40:43], v[160:175]
  ds_read_b64_tr_b16 a[228:229], v5 offset:64
  ds_read_b64_tr_b16 a[230:231], v5 offset:960
  global_load_dwordx4 a[188:191], v79, s[76:77] offset:3072
  s_waitcnt lgkmcnt(8)
  v_mul_f32 v34, 0x41800000, v34
  v_mul_f32 v35, v34, v42
  v_mul_f32_e64 v36, v34, v43
  v_mfma_f32_32x32x16_bf16 v[176:191], a[200:203], a[40:43], v[176:191]
  ds_read_b64_tr_b16 a[232:233], v5 offset:96
  ds_read_b64_tr_b16 a[234:235], v5 offset:992
  v_exp_f32 v35, v35
  v_fract_f32 v36, v36
  v_cos_f32_e64 v48, v36
  v_mfma_f32_32x32x16_bf16 v[192:207], a[204:207], a[40:43], v[192:207]
  ds_read_b64_tr_b16 a[236:237], v5 offset:128
  ds_read_b64_tr_b16 a[238:239], v5 offset:1024
  v_sin_f32 v49, v36
  v_mul_f32 v48, v48, v35
  v_mul_f32 v49, v49, v35
  s_sub_u32 s6, s33, 1
  v_mfma_f32_32x32x16_bf16 v[208:223], a[208:211], a[40:43], v[208:223]
  ds_read_b64_tr_b16 a[240:241], v5 offset:160
  ds_read_b64_tr_b16 a[242:243], v5 offset:1056
  v_sub_u32 v34, s6, v14
  v_max_i32 v34, 0, v34
  v_cvt_f32_u32_e64 v34, v34
  v_mul_f32 v34, 0x43000000, v34
  v_mul_f32_e64 v35, v34, v42
  v_mfma_f32_32x32x16_bf16 v[224:239], a[212:215], a[40:43], v[224:239]
  ds_read_b64_tr_b16 a[244:245], v5 offset:192
  ds_read_b64_tr_b16 a[246:247], v5 offset:1088
  v_add_u32 v5, 0xa800, v5
  s_waitcnt lgkmcnt(8)
  v_mul_f32 v36, v34, v43
  v_exp_f32 v35, v35
  v_mfma_f32_32x32x16_bf16 v[240:255], a[216:219], a[40:43], v[240:255]
  s_barrier
  ds_read_b64_tr_b16 a[200:201], v2 offset:0
  ds_read_b64_tr_b16 a[202:203], v2 offset:896
  v_fract_f32 v36, v36
  v_cos_f32 v50, v36
  v_mfma_f32_32x32x16_bf16 v[144:159], a[220:223], a[44:47], v[144:159]
  ds_read_b64_tr_b16 a[204:205], v2 offset:32
  ds_read_b64_tr_b16 a[206:207], v2 offset:928
  v_sin_f32 v51, v36
  v_mul_f32 v50, v50, v35
  v_mul_f32_e64 v51, v51, v35
  s_sub_u32 s6, s33, 9
  v_mfma_f32_32x32x16_bf16 v[160:175], a[224:227], a[44:47], v[160:175]
  s_add_u32 s45, s35, 6
  s_and_b32 s45, s45, 7
  s_mul_i32 s45, s45, 229376
  s_add_u32 s44, s38, s45
  s_add_u32 m0, s41, 0
  s_nop 0
  buffer_load_dwordx4 v6, s[16:19], s44 offen offset:0 lds
  ds_read_b64_tr_b16 a[208:209], v2 offset:64
  ds_read_b64_tr_b16 a[210:211], v2 offset:960
  v_mfma_f32_32x32x16_bf16 v[176:191], a[228:231], a[44:47], v[176:191]
  ds_read_b64_tr_b16 a[212:213], v2 offset:96
  ds_read_b64_tr_b16 a[214:215], v2 offset:992
  s_waitcnt lgkmcnt(8)
  v_sub_u32 v34, s6, v14
  v_max_i32 v34, 0, v34
  v_cvt_f32_u32 v34, v34
  v_mul_f32 v34, 0x43000000, v34
  v_mfma_f32_32x32x16_bf16 v[192:207], a[232:235], a[44:47], v[192:207]
  ds_read_b64_tr_b16 a[216:217], v2 offset:128
  ds_read_b64_tr_b16 a[218:219], v2 offset:1024
  v_mul_f32 v35, v34, v42
  v_mul_f32 v36, v34, v43
  v_exp_f32 v35, v35
  v_fract_f32 v36, v36
  v_mfma_f32_32x32x16_bf16 v[208:223], a[236:239], a[44:47], v[208:223]
  buffer_load_dwordx4 v7, s[16:19], s44 offen offset:1024 lds
  ds_read_b64_tr_b16 a[220:221], v2 offset:160
  ds_read_b64_tr_b16 a[222:223], v2 offset:1056
  v_cos_f32 v52, v36
  v_sin_f32 v53, v36
  v_mfma_f32_32x32x16_bf16 v[224:239], a[240:243], a[44:47], v[224:239]
  ds_read_b64_tr_b16 a[224:225], v2 offset:192
  ds_read_b64_tr_b16 a[226:227], v2 offset:1088
  v_add_u32 v2, 0x7100, v2
  v_mul_f32_e64 v52, v52, v35
  v_mul_f32 v53, v53, v35
  s_and_b32 s4, s2, 7
  s_lshl_b32 s4, s4, 2
  v_mfma_f32_32x32x16_bf16 v[240:255], a[244:247], a[44:47], v[240:255]
  ds_read_b64_tr_b16 a[228:229], v3 offset:0
  ds_read_b64_tr_b16 a[230:231], v3 offset:896
  s_waitcnt lgkmcnt(8)
  s_lshr_b32 s5, s2, 6
  s_add_u32 s36, s4, s5
  s_bfe_u32 s37, s2, 196611
  s_add_u32 s39, s37, s5
  v_mfma_f32_32x32x16_bf16 v[144:159], a[200:203], a[48:51], v[144:159]
  buffer_load_dwordx4 v8, s[16:19], s44 offen offset:2048 lds
  ds_read_b64_tr_b16 a[232:233], v3 offset:32
  ds_read_b64_tr_b16 a[234:235], v3 offset:928
  s_and_b32 s39, s39, 3
  s_add_u32 s40, s37, s5
  v_mfma_f32_16x16x32_bf16 a[128:131], a[180:183], a[200:203], a[128:131]
  v_mfma_f32_32x32x16_bf16 v[160:175], a[204:207], a[48:51], v[160:175]
  ds_read_b64_tr_b16 a[236:237], v3 offset:64
  ds_read_b64_tr_b16 a[238:239], v3 offset:960
  s_mul_i32 s42, s32, 24576
  s_add_u32 s42, s42, 65536
  s_lshl_b32 s43, s32, 14
  v_mfma_f32_16x16x32_bf16 a[132:135], a[180:183], a[204:207], a[132:135]
  v_mfma_f32_32x32x16_bf16 v[176:191], a[208:211], a[48:51], v[176:191]
  ds_read_b64_tr_b16 a[240:241], v3 offset:96
  ds_read_b64_tr_b16 a[242:243], v3 offset:992
  s_lshl_b32 s4, s36, 17
  s_add_u32 s97, s4, 1048576
  s_mul_i32 s4, s36, 229376
  v_mfma_f32_16x16x32_bf16 a[136:139], a[180:183], a[208:211], a[136:139]
  v_mfma_f32_32x32x16_bf16 v[192:207], a[212:215], a[48:51], v[192:207]
  buffer_load_dwordx4 v9, s[16:19], s44 offen offset:3072 lds
  ds_read_b64_tr_b16 a[244:245], v3 offset:128
  ds_read_b64_tr_b16 a[246:247], v3 offset:1024
  s_waitcnt lgkmcnt(8)
  s_add_u32 s100, s4, 5242880
  v_mfma_f32_16x16x32_bf16 a[140:143], a[180:183], a[212:215], a[140:143]
  v_mfma_f32_32x32x16_bf16 v[208:223], a[216:219], a[48:51], v[208:223]
  ds_read_b64_tr_b16 a[200:201], v3 offset:160
  ds_read_b64_tr_b16 a[202:203], v3 offset:1056
  s_mov_b32 s12, s62
  s_mov_b32 s13, s63
  s_mov_b32 s14, 524288
  v_mfma_f32_16x16x32_bf16 a[144:147], a[180:183], a[216:219], a[144:147]
  v_mfma_f32_32x32x16_bf16 v[224:239], a[220:223], a[48:51], v[224:239]
  ds_read_b64_tr_b16 a[204:205], v3 offset:192
  ds_read_b64_tr_b16 a[206:207], v3 offset:1088
  v_add_u32 v3, 0x7100, v3
  s_mov_b32 s15, 0x20000
  s_mov_b32 s24, s64
  v_mfma_f32_16x16x32_bf16 a[148:151], a[180:183], a[220:223], a[148:151]
  v_mfma_f32_32x32x16_bf16 v[240:255], a[224:227], a[48:51], v[240:255]
  s_add_u32 m0, s41, 4096
  s_nop 0
  buffer_load_dwordx4 v10, s[16:19], s44 offen offset:0 lds
  ds_read_b64_tr_b16 a[208:209], v4 offset:0
  ds_read_b64_tr_b16 a[210:211], v4 offset:896
  buffer_load_dwordx4 v[84:87], v71, s[20:23], 0 offen sc1
  v_mfma_f32_16x16x32_bf16 a[152:155], a[180:183], a[224:227], a[152:155]
  v_mfma_f32_32x32x16_bf16 v[144:159], a[228:231], a[52:55], v[144:159]
  ds_read_b64_tr_b16 a[212:213], v4 offset:32
  ds_read_b64_tr_b16 a[214:215], v4 offset:928
  s_waitcnt lgkmcnt(8)
  buffer_load_dwordx4 v[88:91], v72, s[20:23], 0 offen sc1
  s_mov_b32 s25, s65
  s_mov_b32 s26, 524288
  s_mov_b32 s27, 0x20000
  v_mfma_f32_32x32x16_bf16 v[160:175], a[232:235], a[52:55], v[160:175]
  ds_read_b64_tr_b16 a[216:217], v4 offset:64
  ds_read_b64_tr_b16 a[218:219], v4 offset:960
  s_mov_b32 s28, s62
  s_mov_b32 s29, s63
  s_mov_b32 s30, 524288
  s_mov_b32 s31, 0x20000
  v_and_b32_e64 v34, 7, v1
  v_mfma_f32_32x32x16_bf16 v[176:191], a[236:239], a[52:55], v[176:191]
  buffer_load_dwordx4 v11, s[16:19], s44 offen offset:1024 lds
  ds_read_b64_tr_b16 a[220:221], v4 offset:96
  ds_read_b64_tr_b16 a[222:223], v4 offset:992
  v_lshrrev_b32 v35, 3, v1
  v_lshlrev_b32 v36, 10, v35
  v_lshrrev_b32 v37, 1, v35
  v_xor_b32 v37, v37, v34
  v_mfma_f32_32x32x16_bf16 v[192:207], a[240:243], a[52:55], v[192:207]
  ds_read_b64_tr_b16 a[224:225], v4 offset:128
  ds_read_b64_tr_b16 a[226:227], v4 offset:1024
  v_lshl_add_u32 v17, v37, 4, v36
  v_bfe_u32 v37, v35, 1, 1
  v_xor_b32_e64 v18, 64, v17
  v_add_u32 v18, 0x1c00, v18
  v_lshlrev_b32_e64 v37, 2, v37
  v_mfma_f32_32x32x16_bf16 v[208:223], a[244:247], a[52:55], v[208:223]
  ds_read_b64_tr_b16 a[228:229], v4 offset:160
  ds_read_b64_tr_b16 a[230:231], v4 offset:1056
  s_waitcnt lgkmcnt(8)
  v_xor_b32 v37, v37, v34
  v_lshl_add_u32 v16, v37, 4, v36
  v_add_u32 v39, 0x1c00, v16
  s_lshr_b32 s4, s36, 1
  s_lshl_b32 s4, s4, 10
  v_mfma_f32_32x32x16_bf16 v[224:239], a[200:203], a[52:55], v[224:239]
  buffer_load_dwordx4 v12, s[16:19], s44 offen offset:2048 lds
  ds_read_b64_tr_b16 a[232:233], v4 offset:192
  ds_read_b64_tr_b16 a[234:235], v4 offset:1088
  v_add_u32 v4, 0x7100, v4
  s_add_u32 s4, s4, 196608
  s_lshl_b32 s5, s32, 6
  s_add_u32 s5, s5, s4
  v_bfe_u32 v34, v1, 1, 2
  v_mfma_f32_32x32x16_bf16 v[240:255], a[204:207], a[52:55], v[240:255]
  ds_read_b64_tr_b16 a[236:237], v5 offset:0
  ds_read_b64_tr_b16 a[238:239], v5 offset:896
  v_lshl_add_u32 v34, v34, 4, s5
  v_and_b32_e64 v35, 1, v1
  s_and_b32 s5, s36, 1
  s_lshl_b32 s5, s5, 3
  v_lshl_add_u32 v34, v35, 2, v34
  v_add_u32 v31, s5, v34
  v_mfma_f32_32x32x16_bf16 v[144:159], a[208:211], a[56:59], v[144:159]
  ds_read_b64_tr_b16 a[240:241], v5 offset:32
  ds_read_b64_tr_b16 a[242:243], v5 offset:928
  s_lshl_b32 s4, s33, 10
  s_add_u32 s4, s4, 196608
  s_lshl_b32 s5, s34, 4
  s_add_u32 s4, s4, s5
  s_lshl_b32 s5, s32, 2
  s_add_u32 s4, s4, s5
  v_mfma_f32_32x32x16_bf16 v[160:175], a[212:215], a[56:59], v[160:175]
  ds_read_b64_tr_b16 a[244:245], v5 offset:64
  ds_read_b64_tr_b16 a[246:247], v5 offset:960
  s_waitcnt lgkmcnt(8)
  v_cmp_eq_u32 vcc, 0, v1
  v_mov_b32 v34, 0x70000000
  v_mov_b32 v35, s4
  v_cndmask_b32 v33, v34, v35, vcc
  v_mov_b32_e64 v38, s50
  v_mfma_f32_32x32x16_bf16 v[176:191], a[216:219], a[56:59], v[176:191]
  ds_read_b64_tr_b16 a[200:201], v5 offset:96
  ds_read_b64_tr_b16 a[202:203], v5 offset:992
  v_mfma_f32_32x32x16_bf16 v[192:207], a[220:223], a[56:59], v[192:207]
  ds_read_b64_tr_b16 a[204:205], v5 offset:128
  ds_read_b64_tr_b16 a[206:207], v5 offset:1024
  v_mfma_f32_32x32x16_bf16 v[208:223], a[224:227], a[56:59], v[208:223]
  ds_read_b64_tr_b16 a[208:209], v5 offset:160
  ds_read_b64_tr_b16 a[210:211], v5 offset:1056
  v_mfma_f32_32x32x16_bf16 v[224:239], a[228:231], a[56:59], v[224:239]
  ds_read_b64_tr_b16 a[212:213], v5 offset:192
  ds_read_b64_tr_b16 a[214:215], v5 offset:1088
  v_add_u32 v5, 0x7100, v5
  s_waitcnt lgkmcnt(8)
  v_mfma_f32_32x32x16_bf16 v[240:255], a[232:235], a[56:59], v[240:255]
  s_waitcnt vmcnt(25)
  s_barrier
  ds_read_b64_tr_b16 a[216:217], v2 offset:0
  ds_read_b64_tr_b16 a[218:219], v2 offset:896
K1_LBBACK:
  s_waitcnt vmcnt(3)
  v_cmp_ne_u32 s[88:89], s50, v85
  v_cmp_ne_u32 vcc, s50, v87
  s_waitcnt vmcnt(2)
  v_cmp_ne_u32 s[90:91], s50, v89
  s_nop 1
  s_or_b64 s[88:89], s[88:89], vcc
  v_cmp_ne_u32_e64 vcc, s50, v91
  s_and_b64 s[88:89], s[88:89], s[84:85]
  v_cndmask_b32 v84, 0, v84, s[84:85]
  v_cndmask_b32 v86, 0, v86, s[84:85]
  s_nop 0
  s_or_b64 s[90:91], s[90:91], vcc
  s_and_b64 s[90:91], s[90:91], s[86:87]
  s_or_b64 s[88:89], s[88:89], s[90:91]
  s_cbranch_scc1 K1_LBSPIN
  v_mfma_f32_32x32x16_bf16 v[144:159], a[236:239], a[60:63], v[144:159]
  s_add_u32 s45, s35, 7
  s_and_b32 s45, s45, 7
  s_mul_i32 s45, s45, 229376
  s_add_u32 s44, s38, s45
  s_add_u32 m0, s41, 28928
  s_nop 0
  buffer_load_dwordx4 v6, s[16:19], s44 offen offset:0 lds
  ds_read_b64_tr_b16 a[220:221], v2 offset:32
  ds_read_b64_tr_b16 a[222:223], v2 offset:928
  v_mfma_f32_32x32x16_bf16 v[160:175], a[240:243], a[60:63], v[160:175]
  ds_read_b64_tr_b16 a[224:225], v2 offset:64
  ds_read_b64_tr_b16 a[226:227], v2 offset:960
  v_add_u32 v79, 0x1000, v79
  global_load_dwordx4 a[188:191], v79, s[76:77] offset:0
  v_cndmask_b32 v88, 0, v88, s[86:87]
  v_cndmask_b32 v90, 0, v90, s[86:87]
  v_mul_f32_e64 v80, v50, v84
  v_mul_f32 v81, v50, v86
  v_mfma_f32_32x32x16_bf16 v[176:191], a[244:247], a[60:63], v[176:191]
  ds_read_b64_tr_b16 a[228:229], v2 offset:96
  ds_read_b64_tr_b16 a[230:231], v2 offset:992
  s_waitcnt lgkmcnt(8)
  v_fma_f32 v80, -v51, v86, v80
  v_fma_f32 v81, v51, v84, v81
  v_fma_f32 v80, v52, v88, v80
  v_fma_f32 v81, v52, v90, v81
  v_fma_f32 v80, -v53, v90, v80
  v_mfma_f32_32x32x16_bf16 v[192:207], a[200:203], a[60:63], v[192:207]
  buffer_load_dwordx4 v7, s[16:19], s44 offen offset:1024 lds
  ds_read_b64_tr_b16 a[232:233], v2 offset:128
  ds_read_b64_tr_b16 a[234:235], v2 offset:1024
  v_fma_f32 v81, v53, v88, v81
  ds_write_b64 v68, v[80:81] offset:2048
  v_mfma_f32_32x32x16_bf16 v[208:223], a[204:207], a[60:63], v[208:223]
  ds_read_b64_tr_b16 a[236:237], v2 offset:160
  ds_read_b64_tr_b16 a[238:239], v2 offset:1056
  global_load_dwordx4 a[188:191], v79, s[76:77] offset:1024
  v_mfma_f32_32x32x16_bf16 v[224:239], a[208:211], a[60:63], v[224:239]
  ds_read_b64_tr_b16 a[240:241], v2 offset:192
  ds_read_b64_tr_b16 a[242:243], v2 offset:1088
  v_add_u32 v2, 0x7100, v2
  v_mfma_f32_32x32x16_bf16 v[240:255], a[212:215], a[60:63], v[240:255]
  buffer_load_dwordx4 v8, s[16:19], s44 offen offset:2048 lds
  ds_read_b64_tr_b16 a[244:245], v3 offset:0
  ds_read_b64_tr_b16 a[246:247], v3 offset:896
  s_waitcnt lgkmcnt(6)
  s_barrier
  ds_read_b64 v[84:85], v69 offset:2048
  ds_read_b64 v[86:87], v69 offset:2304
  v_mfma_f32_32x32x16_bf16 v[144:159], a[216:219], a[64:67], v[144:159]
  ds_read_b64_tr_b16 a[200:201], v3 offset:32
  ds_read_b64_tr_b16 a[202:203], v3 offset:928
  global_load_dwordx4 a[188:191], v79, s[76:77] offset:2048
  ds_read_b64 v[88:89], v69 offset:2560
  ds_read_b64 v[90:91], v69 offset:2816
  ds_read_b64 v[92:93], v69 offset:3072
  v_mfma_f32_16x16x32_bf16 a[128:131], a[180:183], a[216:219], a[128:131]
  v_mfma_f32_32x32x16_bf16 v[160:175], a[220:223], a[64:67], v[160:175]
  ds_read_b64_tr_b16 a[204:205], v3 offset:64
  ds_read_b64_tr_b16 a[206:207], v3 offset:960
  ds_read_b64 v[94:95], v69 offset:3328
  ds_read_b64 v[96:97], v69 offset:3584
  ds_read_b64 v[98:99], v69 offset:3840
  v_mfma_f32_16x16x32_bf16 a[132:135], a[180:183], a[220:223], a[132:135]
  v_mfma_f32_32x32x16_bf16 v[176:191], a[224:227], a[64:67], v[176:191]
  buffer_load_dwordx4 v9, s[16:19], s44 offen offset:3072 lds
  ds_read_b64_tr_b16 a[208:209], v3 offset:96
  ds_read_b64_tr_b16 a[210:211], v3 offset:992
  v_mfma_f32_16x16x32_bf16 a[136:139], a[180:183], a[224:227], a[136:139]
  v_mfma_f32_32x32x16_bf16 v[192:207], a[228:231], a[64:67], v[192:207]
  ds_read_b64_tr_b16 a[212:213], v3 offset:128
  ds_read_b64_tr_b16 a[214:215], v3 offset:1024
  global_load_dwordx4 a[188:191], v79, s[76:77] offset:3072
  s_waitcnt lgkmcnt(15)
  s_waitcnt lgkmcnt(14)
  v_add_f32 v84, v84, v86
  v_add_f32 v85, v85, v87
  v_mfma_f32_16x16x32_bf16 a[140:143], a[180:183], a[228:231], a[140:143]
  v_mfma_f32_32x32x16_bf16 v[208:223], a[232:235], a[64:67], v[208:223]
  ds_read_b64_tr_b16 a[216:217], v3 offset:160
  ds_read_b64_tr_b16 a[218:219], v3 offset:1056
  s_waitcnt lgkmcnt(12)
  v_add_f32 v88, v88, v90
  v_add_f32 v89, v89, v91
  s_waitcnt lgkmcnt(8)
  v_add_f32_e64 v92, v92, v94
  v_add_f32 v93, v93, v95
  v_mfma_f32_16x16x32_bf16 a[144:147], a[180:183], a[232:235], a[144:147]
  v_mfma_f32_32x32x16_bf16 v[224:239], a[236:239], a[64:67], v[224:239]
  s_add_u32 m0, s41, 33024
  s_nop 0
  buffer_load_dwordx4 v10, s[16:19], s44 offen offset:0 lds
  ds_read_b64_tr_b16 a[220:221], v3 offset:192
  ds_read_b64_tr_b16 a[222:223], v3 offset:1088
  v_add_u32 v3, 0x7100, v3
  s_waitcnt lgkmcnt(8)
  v_add_f32 v96, v96, v98
  v_mfma_f32_16x16x32_bf16 a[148:151], a[180:183], a[236:239], a[148:151]
  v_mfma_f32_32x32x16_bf16 v[240:255], a[240:243], a[64:67], v[240:255]
  ds_read_b64_tr_b16 a[224:225], v4 offset:0
  ds_read_b64_tr_b16 a[226:227], v4 offset:896
  v_add_u32 v79, 0x1000, v79
  global_load_dwordx4 a[188:191], v79, s[76:77] offset:0
  v_add_f32 v97, v97, v99
  v_add_f32 v84, v84, v88
  v_mfma_f32_16x16x32_bf16 a[152:155], a[180:183], a[240:243], a[152:155]
  v_mfma_f32_32x32x16_bf16 v[144:159], a[244:247], a[68:71], v[144:159]
  ds_read_b64_tr_b16 a[228:229], v4 offset:32
  ds_read_b64_tr_b16 a[230:231], v4 offset:928
  s_waitcnt lgkmcnt(8)
  v_add_f32 v85, v85, v89
  v_add_f32 v92, v92, v96
  v_add_f32 v93, v93, v97
  v_add_f32 v84, v84, v92
  v_add_f32 v85, v85, v93
  v_mfma_f32_32x32x16_bf16 v[160:175], a[200:203], a[68:71], v[160:175]
  buffer_load_dwordx4 v11, s[16:19], s44 offen offset:1024 lds
  ds_read_b64_tr_b16 a[232:233], v4 offset:64
  ds_read_b64_tr_b16 a[234:235], v4 offset:960
  v_fma_f32 v80, v48, v84, v100
  v_fma_f32 v81, v48, v85, v101
  v_fma_f32 v80, -v49, v85, v80
  v_fma_f32 v81, v49, v84, v81
  v_fma_f32 v82, v40, v80, v112
  v_mfma_f32_32x32x16_bf16 v[176:191], a[204:207], a[68:71], v[176:191]
  ds_read_b64_tr_b16 a[236:237], v4 offset:96
  ds_read_b64_tr_b16 a[238:239], v4 offset:992
  global_load_dwordx4 a[188:191], v79, s[76:77] offset:1024
  v_fma_f32 v83, v40, v81, v128
  v_fma_f32 v82, -v41, v81, v82
  v_fma_f32 v83, v41, v80, v83
  v_mul_f32 v112, v44, v82
  v_mul_f32 v128, v44, v83
  v_mfma_f32_32x32x16_bf16 v[192:207], a[208:211], a[68:71], v[192:207]
  ds_read_b64_tr_b16 a[240:241], v4 offset:128
  ds_read_b64_tr_b16 a[242:243], v4 offset:1024
  v_fma_f32 v112, -v45, v83, v112
  v_fma_f32 v128, v45, v82, v128
  v_fma_f32 v80, v40, v82, v113
  v_fma_f32 v81, v40, v83, v129
  v_fma_f32 v80, -v41, v83, v80
  v_fma_f32 v81, v41, v82, v81
  v_mfma_f32_32x32x16_bf16 v[208:223], a[212:215], a[68:71], v[208:223]
  buffer_load_dwordx4 v12, s[16:19], s44 offen offset:2048 lds
  ds_read_b64_tr_b16 a[244:245], v4 offset:160
  ds_read_b64_tr_b16 a[246:247], v4 offset:1056
  s_waitcnt lgkmcnt(8)
  v_mul_f32 v113, v44, v80
  v_mul_f32_e64 v129, v44, v81
  v_fma_f32 v113, -v45, v81, v113
  v_fma_f32 v129, v45, v80, v129
  v_mfma_f32_32x32x16_bf16 v[224:239], a[216:219], a[68:71], v[224:239]
  ds_read_b64_tr_b16 a[200:201], v4 offset:192
  ds_read_b64_tr_b16 a[202:203], v4 offset:1088
  v_add_u32 v4, 0x7100, v4
  global_load_dwordx4 a[188:191], v79, s[76:77] offset:2048
  v_cvt_pk_bf16_f32 v84, v112, v113
  v_cvt_pk_bf16_f32 v92, -v128, -v129
  v_fma_f32 v82, v40, v80, v114
  v_fma_f32 v83, v40, v81, v130
  v_mfma_f32_32x32x16_bf16 v[240:255], a[220:223], a[68:71], v[240:255]
  ds_read_b64_tr_b16 a[204:205], v5 offset:0
  ds_read_b64_tr_b16 a[206:207], v5 offset:896
  v_fma_f32 v82, -v41, v81, v82
  v_fma_f32 v83, v41, v80, v83
  v_mul_f32 v114, v44, v82
  v_mul_f32 v130, v44, v83
  v_fma_f32 v114, -v45, v83, v114
  v_fma_f32 v130, v45, v82, v130
  v_mfma_f32_32x32x16_bf16 v[144:159], a[224:227], a[72:75], v[144:159]
  ds_read_b64_tr_b16 a[208:209], v5 offset:32
  ds_read_b64_tr_b16 a[210:211], v5 offset:928
  v_fma_f32 v80, v40, v82, v115
  v_fma_f32 v81, v40, v83, v131
  v_fma_f32 v80, -v41, v83, v80
  v_fma_f32 v81, v41, v82, v81
  v_mul_f32_e64 v115, v44, v80
  v_mul_f32 v131, v44, v81
  v_mfma_f32_32x32x16_bf16 v[160:175], a[228:231], a[72:75], v[160:175]
  ds_read_b64_tr_b16 a[212:213], v5 offset:64
  ds_read_b64_tr_b16 a[214:215], v5 offset:960
  global_load_dwordx4 a[188:191], v79, s[76:77] offset:3072
  s_waitcnt lgkmcnt(8)
  v_fma_f32 v115, -v45, v81, v115
  v_fma_f32 v131, v45, v80, v131
  v_cvt_pk_bf16_f32 v85, v114, v115
  v_cvt_pk_bf16_f32 v93, -v130, -v131
  v_mfma_f32_32x32x16_bf16 v[176:191], a[232:235], a[72:75], v[176:191]
  ds_read_b64_tr_b16 a[216:217], v5 offset:96
  ds_read_b64_tr_b16 a[218:219], v5 offset:992
  v_fma_f32 v82, v40, v80, v116
  v_fma_f32 v83, v40, v81, v132
  v_fma_f32 v82, -v41, v81, v82
  v_fma_f32 v83, v41, v80, v83
  v_mul_f32 v116, v44, v82
  v_mul_f32 v132, v44, v83
  v_mfma_f32_32x32x16_bf16 v[192:207], a[236:239], a[72:75], v[192:207]
  ds_read_b64_tr_b16 a[220:221], v5 offset:128
  ds_read_b64_tr_b16 a[222:223], v5 offset:1024
  v_fma_f32 v116, -v45, v83, v116
  v_fma_f32 v132, v45, v82, v132
  v_fma_f32 v80, v40, v82, v117
  v_fma_f32 v81, v40, v83, v133
  v_fma_f32 v80, -v41, v83, v80
  v_fma_f32 v81, v41, v82, v81
  v_mfma_f32_32x32x16_bf16 v[208:223], a[240:243], a[72:75], v[208:223]
  ds_read_b64_tr_b16 a[224:225], v5 offset:160
  ds_read_b64_tr_b16 a[226:227], v5 offset:1056
  v_add_u32 v79, 0x1000, v79
  global_load_dwordx4 a[188:191], v79, s[76:77] offset:0
  v_mul_f32 v117, v44, v80
  v_mul_f32 v133, v44, v81
  v_fma_f32 v117, -v45, v81, v117
  v_fma_f32 v133, v45, v80, v133
  v_mfma_f32_32x32x16_bf16 v[224:239], a[244:247], a[72:75], v[224:239]
  ds_read_b64_tr_b16 a[228:229], v5 offset:192
  ds_read_b64_tr_b16 a[230:231], v5 offset:1088
  v_add_u32 v5, 0x7100, v5
  s_waitcnt lgkmcnt(8)
  v_cvt_pk_bf16_f32 v86, v116, v117
  v_cvt_pk_bf16_f32 v94, -v132, -v133
  v_fma_f32 v82, v40, v80, v118
  v_fma_f32 v83, v40, v81, v134
  v_mfma_f32_32x32x16_bf16 v[240:255], a[200:203], a[72:75], v[240:255]
  s_barrier
  ds_read_b64_tr_b16 a[232:233], v2 offset:0
  ds_read_b64_tr_b16 a[234:235], v2 offset:896
  v_fma_f32 v82, -v41, v81, v82
  v_fma_f32 v83, v41, v80, v83
  v_mul_f32 v118, v44, v82
  v_mul_f32 v134, v44, v83
  v_mfma_f32_32x32x16_bf16 v[144:159], a[204:207], a[76:79], v[144:159]
  ds_read_b64_tr_b16 a[236:237], v2 offset:32
  ds_read_b64_tr_b16 a[238:239], v2 offset:928
  global_load_dwordx4 a[188:191], v79, s[76:77] offset:1024
  v_fma_f32 v118, -v45, v83, v118
  v_fma_f32 v134, v45, v82, v134
  v_fma_f32 v80, v40, v82, v119
  v_fma_f32 v81, v40, v83, v135
  v_fma_f32 v80, -v41, v83, v80
  v_mfma_f32_32x32x16_bf16 v[160:175], a[208:211], a[76:79], v[160:175]
  ds_read_b64_tr_b16 a[240:241], v2 offset:64
  ds_read_b64_tr_b16 a[242:243], v2 offset:960
  v_fma_f32 v81, v41, v82, v81
  v_mul_f32_e64 v119, v44, v80
  v_mul_f32 v135, v44, v81
  v_fma_f32 v119, -v45, v81, v119
  v_fma_f32 v135, v45, v80, v135
  v_cvt_pk_bf16_f32 v87, v118, v119
  v_mfma_f32_32x32x16_bf16 v[176:191], a[212:215], a[76:79], v[176:191]
  ds_read_b64_tr_b16 a[244:245], v2 offset:96
  ds_read_b64_tr_b16 a[246:247], v2 offset:992
  s_waitcnt lgkmcnt(8)
  v_cvt_pk_bf16_f32 v95, -v134, -v135
  v_fma_f32 v82, v40, v80, v120
  v_fma_f32 v83, v40, v81, v136
  v_fma_f32 v82, -v41, v81, v82
  v_fma_f32 v83, v41, v80, v83
  v_mfma_f32_32x32x16_bf16 v[192:207], a[216:219], a[76:79], v[192:207]
  ds_read_b64_tr_b16 a[200:201], v2 offset:128
  ds_read_b64_tr_b16 a[202:203], v2 offset:1024
  v_mul_f32 v120, v44, v82
  v_mul_f32 v136, v44, v83
  v_fma_f32 v120, -v45, v83, v120
  v_fma_f32 v136, v45, v82, v136
  v_fma_f32 v80, v40, v82, v121
  v_fma_f32 v81, v40, v83, v137
  v_mfma_f32_32x32x16_bf16 v[208:223], a[220:223], a[76:79], v[208:223]
  ds_read_b64_tr_b16 a[204:205], v2 offset:160
  ds_read_b64_tr_b16 a[206:207], v2 offset:1056
  v_fma_f32 v80, -v41, v83, v80
  v_fma_f32 v81, v41, v82, v81
  v_mul_f32 v121, v44, v80
  v_mul_f32 v137, v44, v81
  v_fma_f32 v121, -v45, v81, v121
  v_fma_f32 v137, v45, v80, v137
  v_mfma_f32_32x32x16_bf16 v[224:239], a[224:227], a[76:79], v[224:239]
  ds_read_b64_tr_b16 a[208:209], v2 offset:192
  ds_read_b64_tr_b16 a[210:211], v2 offset:1088
  v_add_u32 v2, 0xfffe0500, v2
  v_add_u32 v6, 0x7100, v2
  v_cvt_pk_bf16_f32 v88, v120, v121
  v_cvt_pk_bf16_f32 v96, -v136, -v137
  v_fma_f32 v82, v40, v80, v122
  v_fma_f32 v83, v40, v81, v138
  v_mfma_f32_32x32x16_bf16 v[240:255], a[228:231], a[76:79], v[240:255]
  ds_read_b64_tr_b16 a[212:213], v3 offset:0
  ds_read_b64_tr_b16 a[214:215], v3 offset:896
  s_waitcnt lgkmcnt(8)
  v_fma_f32 v82, -v41, v81, v82
  v_fma_f32 v83, v41, v80, v83
  v_mul_f32 v122, v44, v82
  v_mul_f32_e64 v138, v44, v83
  v_fma_f32 v122, -v45, v83, v122
  v_mfma_f32_32x32x16_bf16 v[144:159], a[232:235], a[80:83], v[144:159]
  ds_read_b64_tr_b16 a[216:217], v3 offset:32
  ds_read_b64_tr_b16 a[218:219], v3 offset:928
  v_fma_f32 v138, v45, v82, v138
  v_fma_f32 v80, v40, v82, v123
  v_fma_f32 v81, v40, v83, v139
  v_fma_f32 v80, -v41, v83, v80
  v_mfma_f32_16x16x32_bf16 a[128:131], a[180:183], a[232:235], a[128:131]
  v_mfma_f32_32x32x16_bf16 v[160:175], a[236:239], a[80:83], v[160:175]
  ds_read_b64_tr_b16 a[220:221], v3 offset:64
  ds_read_b64_tr_b16 a[222:223], v3 offset:960
  v_fma_f32 v81, v41, v82, v81
  v_mul_f32 v123, v44, v80
  v_mul_f32 v139, v44, v81
  v_fma_f32 v123, -v45, v81, v123
  v_mfma_f32_16x16x32_bf16 a[132:135], a[180:183], a[236:239], a[132:135]
  v_mfma_f32_32x32x16_bf16 v[176:191], a[240:243], a[80:83], v[176:191]
  ds_read_b64_tr_b16 a[224:225], v3 offset:96
  ds_read_b64_tr_b16 a[226:227], v3 offset:992
  v_fma_f32 v139, v45, v80, v139
  v_cvt_pk_bf16_f32 v89, v122, v123
  v_cvt_pk_bf16_f32 v97, -v138, -v139
  v_fma_f32 v82, v40, v80, v124
  v_mfma_f32_16x16x32_bf16 a[136:139], a[180:183], a[240:243], a[136:139]
  v_mfma_f32_32x32x16_bf16 v[192:207], a[244:247], a[80:83], v[192:207]
  ds_read_b64_tr_b16 a[228:229], v3 offset:128
  ds_read_b64_tr_b16 a[230:231], v3 offset:1024
  s_waitcnt lgkmcnt(8)
  v_fma_f32 v83, v40, v81, v140
  v_fma_f32 v82, -v41, v81, v82
  v_fma_f32 v83, v41, v80, v83
  v_mfma_f32_16x16x32_bf16 a[140:143], a[180:183], a[244:247], a[140:143]
  v_mfma_f32_32x32x16_bf16 v[208:223], a[200:203], a[80:83], v[208:223]
  ds_read_b64_tr_b16 a[232:233], v3 offset:160
  ds_read_b64_tr_b16 a[234:235], v3 offset:1056
  v_mul_f32 v124, v44, v82
  v_mul_f32_e64 v140, v44, v83
  v_fma_f32 v124, -v45, v83, v124
  v_fma_f32 v140, v45, v82, v140
  v_mfma_f32_16x16x32_bf16 a[144:147], a[180:183], a[200:203], a[144:147]
  v_mfma_f32_32x32x16_bf16 v[224:239], a[204:207], a[80:83], v[224:239]
  ds_read_b64_tr_b16 a[236:237], v3 offset:192
  ds_read_b64_tr_b16 a[238:239], v3 offset:1088
  v_add_u32 v3, 0xfffe0500, v3
  v_add_u32 v7, 0x7100, v3
  v_fma_f32 v80, v40, v82, v125
  v_fma_f32 v81, v40, v83, v141
  v_mfma_f32_16x16x32_bf16 a[148:151], a[180:183], a[204:207], a[148:151]
  v_mfma_f32_32x32x16_bf16 v[240:255], a[208:211], a[80:83], v[240:255]
  ds_read_b64_tr_b16 a[240:241], v4 offset:0
  ds_read_b64_tr_b16 a[242:243], v4 offset:896
  v_fma_f32 v80, -v41, v83, v80
  v_fma_f32 v81, v41, v82, v81
  v_mul_f32_e64 v125, v44, v80
  v_mul_f32 v141, v44, v81
  v_mfma_f32_16x16x32_bf16 a[152:155], a[180:183], a[208:211], a[152:155]
  v_mfma_f32_32x32x16_bf16 v[144:159], a[212:215], a[84:87], v[144:159]
  ds_read_b64_tr_b16 a[244:245], v4 offset:32
  ds_read_b64_tr_b16 a[246:247], v4 offset:928
  s_waitcnt lgkmcnt(8)
  v_fma_f32 v125, -v45, v81, v125
  v_fma_f32 v141, v45, v80, v141
  v_cvt_pk_bf16_f32 v90, v124, v125
  v_cvt_pk_bf16_f32 v98, -v140, -v141
  v_fma_f32 v82, v40, v80, v126
  v_mfma_f32_32x32x16_bf16 v[160:175], a[216:219], a[84:87], v[160:175]
  ds_read_b64_tr_b16 a[200:201], v4 offset:64
  ds_read_b64_tr_b16 a[202:203], v4 offset:960
  v_fma_f32 v83, v40, v81, v142
  v_fma_f32 v82, -v41, v81, v82
  v_fma_f32 v83, v41, v80, v83
  v_mul_f32 v126, v44, v82
  v_mul_f32 v142, v44, v83
  v_fma_f32 v126, -v45, v83, v126
  v_mfma_f32_32x32x16_bf16 v[176:191], a[220:223], a[84:87], v[176:191]
  ds_read_b64_tr_b16 a[204:205], v4 offset:96
  ds_read_b64_tr_b16 a[206:207], v4 offset:992
  v_fma_f32 v142, v45, v82, v142
  v_fma_f32 v80, v40, v82, v127
  v_fma_f32 v81, v40, v83, v143
  v_fma_f32 v80, -v41, v83, v80
  v_fma_f32 v81, v41, v82, v81
  v_mul_f32_e64 v127, v44, v80
  v_mfma_f32_32x32x16_bf16 v[192:207], a[224:227], a[84:87], v[192:207]
  ds_read_b64_tr_b16 a[208:209], v4 offset:128
  ds_read_b64_tr_b16 a[210:211], v4 offset:1024
  v_mul_f32 v143, v44, v81
  v_fma_f32 v127, -v45, v81, v127
  v_fma_f32 v143, v45, v80, v143
  v_cvt_pk_bf16_f32 v91, v126, v127
  v_cvt_pk_bf16_f32 v99, -v142, -v143
  ds_write_b128 v73, v[84:87]
  v_mfma_f32_32x32x16_bf16 v[208:223], a[228:231], a[84:87], v[208:223]
  ds_read_b64_tr_b16 a[212:213], v4 offset:160
  ds_read_b64_tr_b16 a[214:215], v4 offset:1056
  s_waitcnt lgkmcnt(9)
  ds_write_b128 v73, v[88:91] offset:16
  ds_write_b128 v73, v[92:95] offset:2560
  ds_write_b128 v73, v[96:99] offset:2576
  ds_read_b64_tr_b16 v[84:85], v74 offset:0
  ds_read_b64_tr_b16 v[86:87], v74 offset:320
  v_mfma_f32_32x32x16_bf16 v[224:239], a[232:235], a[84:87], v[224:239]
  ds_read_b64_tr_b16 a[216:217], v4 offset:192
  ds_read_b64_tr_b16 a[218:219], v4 offset:1088
  v_add_u32 v4, 0xfffe0500, v4
  v_add_u32 v8, 0x7100, v4
  ds_read_b64_tr_b16 v[88:89], v74 offset:1280
  ds_read_b64_tr_b16 v[90:91], v74 offset:1600
  ds_read_b64_tr_b16 v[92:93], v74 offset:2560
  ds_read_b64_tr_b16 v[94:95], v74 offset:2880
  v_mfma_f32_32x32x16_bf16 v[240:255], a[236:239], a[84:87], v[240:255]
  ds_read_b64_tr_b16 a[220:221], v5 offset:0
  ds_read_b64_tr_b16 a[222:223], v5 offset:896
  ds_read_b64_tr_b16 v[96:97], v74 offset:3840
  ds_read_b64_tr_b16 v[98:99], v74 offset:4160
  v_mfma_f32_32x32x16_bf16 v[144:159], a[240:243], a[88:91], v[144:159]
  ds_read_b64_tr_b16 a[224:225], v5 offset:32
  ds_read_b64_tr_b16 a[226:227], v5 offset:928
  v_mfma_f32_32x32x16_bf16 v[160:175], a[244:247], a[88:91], v[160:175]
  ds_read_b64_tr_b16 a[228:229], v5 offset:64
  ds_read_b64_tr_b16 a[230:231], v5 offset:960
  s_waitcnt lgkmcnt(15)
  v_mfma_f32_32x32x16_bf16 v[176:191], a[200:203], a[88:91], v[176:191]
  ds_read_b64_tr_b16 a[232:233], v5 offset:96
  ds_read_b64_tr_b16 a[234:235], v5 offset:992
  s_add_u32 s46, s93, 0
  s_waitcnt lgkmcnt(15)
  buffer_store_dwordx4 v[84:87], v15, s[20:23], s46 offen sc1
  s_add_u32 s46, s93, 1024
  s_waitcnt lgkmcnt(12)
  buffer_store_dwordx4 v[88:91], v15, s[20:23], s46 offen sc1
  s_add_u32 s46, s93, 2048
  s_waitcnt lgkmcnt(10)
  buffer_store_dwordx4 v[92:95], v15, s[20:23], s46 offen sc1
  v_mfma_f32_32x32x16_bf16 v[192:207], a[204:207], a[88:91], v[192:207]
  ds_read_b64_tr_b16 a[236:237], v5 offset:128
  ds_read_b64_tr_b16 a[238:239], v5 offset:1024
  s_add_u32 s46, s93, 3072
  s_waitcnt lgkmcnt(8)
  buffer_store_dwordx4 v[96:99], v15, s[20:23], s46 offen sc1
  v_mfma_f32_32x32x16_bf16 v[208:223], a[208:211], a[88:91], v[208:223]
  ds_read_b64_tr_b16 a[240:241], v5 offset:160
  ds_read_b64_tr_b16 a[242:243], v5 offset:1056
  v_mfma_f32_32x32x16_bf16 v[224:239], a[212:215], a[88:91], v[224:239]
  ds_read_b64_tr_b16 a[244:245], v5 offset:192
  ds_read_b64_tr_b16 a[246:247], v5 offset:1088
  v_add_u32 v5, 0xfffe0500, v5
  v_add_u32 v9, 0x7100, v5
  s_waitcnt lgkmcnt(8)
  v_mfma_f32_32x32x16_bf16 v[240:255], a[216:219], a[88:91], v[240:255]
  s_waitcnt vmcnt(21)
  s_barrier
  ds_read_b64_tr_b16 a[200:201], v2 offset:0
  ds_read_b64_tr_b16 a[202:203], v2 offset:896
  v_mfma_f32_32x32x16_bf16 v[144:159], a[220:223], a[92:95], v[144:159]
  ds_read_b64_tr_b16 a[204:205], v2 offset:32
  ds_read_b64_tr_b16 a[206:207], v2 offset:928
  v_mfma_f32_32x32x16_bf16 v[160:175], a[224:227], a[92:95], v[160:175]
  ds_read_b64_tr_b16 a[208:209], v2 offset:64
  ds_read_b64_tr_b16 a[210:211], v2 offset:960
  v_mfma_f32_32x32x16_bf16 v[176:191], a[228:231], a[92:95], v[176:191]
  ds_read_b64_tr_b16 a[212:213], v2 offset:96
  ds_read_b64_tr_b16 a[214:215], v2 offset:992
  s_waitcnt lgkmcnt(8)
  v_mfma_f32_32x32x16_bf16 v[192:207], a[232:235], a[92:95], v[192:207]
  ds_read_b64_tr_b16 a[216:217], v2 offset:128
  ds_read_b64_tr_b16 a[218:219], v2 offset:1024
  v_mfma_f32_32x32x16_bf16 v[208:223], a[236:239], a[92:95], v[208:223]
  ds_read_b64_tr_b16 a[220:221], v2 offset:160
  ds_read_b64_tr_b16 a[222:223], v2 offset:1056
  v_mfma_f32_32x32x16_bf16 v[224:239], a[240:243], a[92:95], v[224:239]
  ds_read_b64_tr_b16 a[224:225], v2 offset:192
  ds_read_b64_tr_b16 a[226:227], v2 offset:1088
  v_mfma_f32_32x32x16_bf16 v[240:255], a[244:247], a[92:95], v[240:255]
  s_waitcnt vmcnt(8)
  s_barrier
  ds_read_b64_tr_b16 a[228:229], v6 offset:0
  ds_read_b64_tr_b16 a[230:231], v6 offset:896
  s_waitcnt lgkmcnt(8)
  v_mfma_f32_32x32x16_bf16 v[144:159], a[200:203], a[96:99], v[144:159]
  ds_read_b64_tr_b16 a[232:233], v6 offset:32
  ds_read_b64_tr_b16 a[234:235], v6 offset:928
  v_mfma_f32_16x16x32_bf16 a[128:131], a[180:183], a[200:203], a[128:131]
  v_mfma_f32_32x32x16_bf16 v[160:175], a[204:207], a[96:99], v[160:175]
  ds_read_b64_tr_b16 a[236:237], v6 offset:64
  ds_read_b64_tr_b16 a[238:239], v6 offset:960
  v_mfma_f32_16x16x32_bf16 a[132:135], a[180:183], a[204:207], a[132:135]
  v_mfma_f32_32x32x16_bf16 v[176:191], a[208:211], a[96:99], v[176:191]
  ds_read_b64_tr_b16 a[240:241], v6 offset:96
  ds_read_b64_tr_b16 a[242:243], v6 offset:992
  v_mfma_f32_16x16x32_bf16 a[136:139], a[180:183], a[208:211], a[136:139]
  v_mfma_f32_32x32x16_bf16 v[192:207], a[212:215], a[96:99], v[192:207]
  ds_read_b64_tr_b16 a[244:245], v6 offset:128
  ds_read_b64_tr_b16 a[246:247], v6 offset:1024
  s_waitcnt lgkmcnt(8)
  v_mfma_f32_16x16x32_bf16 a[140:143], a[180:183], a[212:215], a[140:143]
  v_mfma_f32_32x32x16_bf16 v[208:223], a[216:219], a[96:99], v[208:223]
  ds_read_b64_tr_b16 a[200:201], v6 offset:160
  ds_read_b64_tr_b16 a[202:203], v6 offset:1056
  v_mfma_f32_16x16x32_bf16 a[144:147], a[180:183], a[216:219], a[144:147]
  v_mfma_f32_32x32x16_bf16 v[224:239], a[220:223], a[96:99], v[224:239]
  ds_read_b64_tr_b16 a[204:205], v6 offset:192
  ds_read_b64_tr_b16 a[206:207], v6 offset:1088
  v_mfma_f32_16x16x32_bf16 a[148:151], a[180:183], a[220:223], a[148:151]
  v_mfma_f32_32x32x16_bf16 v[240:255], a[224:227], a[96:99], v[240:255]
  ds_read_b64_tr_b16 a[208:209], v3 offset:0
  ds_read_b64_tr_b16 a[210:211], v3 offset:896
  v_mfma_f32_16x16x32_bf16 a[152:155], a[180:183], a[224:227], a[152:155]
  v_mfma_f32_32x32x16_bf16 v[144:159], a[228:231], a[112:115], v[144:159]
  ds_read_b64_tr_b16 a[212:213], v4 offset:0
  ds_read_b64_tr_b16 a[214:215], v4 offset:896
  s_waitcnt lgkmcnt(8)
  v_mfma_f32_16x16x32_bf16 a[128:131], a[180:183], a[228:231], a[128:131]
  v_mfma_f32_32x32x16_bf16 v[160:175], a[232:235], a[112:115], v[160:175]
  ds_read_b64_tr_b16 a[216:217], v5 offset:0
  ds_read_b64_tr_b16 a[218:219], v5 offset:896
  v_mfma_f32_16x16x32_bf16 a[132:135], a[180:183], a[232:235], a[132:135]
  v_mfma_f32_32x32x16_bf16 v[176:191], a[236:239], a[112:115], v[176:191]
  ds_read_b64_tr_b16 a[220:221], v7 offset:0
  ds_read_b64_tr_b16 a[222:223], v7 offset:896
  s_nop 0
  ds_write_b32 v58, a128 offset:0
  ds_write_b32 v58, a129 offset:256
  v_mfma_f32_16x16x32_bf16 a[136:139], a[180:183], a[236:239], a[136:139]
  v_mfma_f32_32x32x16_bf16 v[192:207], a[240:243], a[112:115], v[192:207]
  ds_read_b64_tr_b16 a[224:225], v8 offset:0
  ds_read_b64_tr_b16 a[226:227], v8 offset:896
  ds_write_b32 v58, a132 offset:512
  ds_write_b32 v58, a133 offset:768
  v_mfma_f32_16x16x32_bf16 a[140:143], a[180:183], a[240:243], a[140:143]
  v_mfma_f32_32x32x16_bf16 v[208:223], a[244:247], a[112:115], v[208:223]
  ds_read_b64_tr_b16 a[228:229], v9 offset:0
  ds_read_b64_tr_b16 a[230:231], v9 offset:896
  ds_write_b32 v58, a136 offset:1024
  ds_write_b32 v58, a137 offset:1280
  s_waitcnt lgkmcnt(14)
  v_mfma_f32_16x16x32_bf16 a[144:147], a[180:183], a[244:247], a[144:147]
  v_mfma_f32_32x32x16_bf16 v[224:239], a[200:203], a[112:115], v[224:239]
  ds_read_b64_tr_b16 a[232:233], v3 offset:32
  ds_read_b64_tr_b16 a[234:235], v3 offset:928
  ds_write_b32 v58, a140 offset:1536
  ds_write_b32 v58, a141 offset:1792
  v_mfma_f32_16x16x32_bf16 a[148:151], a[180:183], a[200:203], a[148:151]
  v_mfma_f32_32x32x16_bf16 v[240:255], a[204:207], a[112:115], v[240:255]
  ds_read_b64_tr_b16 a[236:237], v4 offset:32
  ds_read_b64_tr_b16 a[238:239], v4 offset:928
  ds_write_b32 v58, a144 offset:2048
  ds_write_b32 v58, a145 offset:2304
  v_mfma_f32_16x16x32_bf16 a[152:155], a[180:183], a[204:207], a[152:155]
  v_mfma_f32_32x32x16_bf16 v[144:159], a[208:211], a[100:103], v[144:159]
  ds_read_b64_tr_b16 a[240:241], v5 offset:32
  ds_read_b64_tr_b16 a[242:243], v5 offset:928
  ds_write_b32 v58, a148 offset:2560
  ds_write_b32 v58, a149 offset:2816
  v_mfma_f32_32x32x16_bf16 v[144:159], a[212:215], a[104:107], v[144:159]
  ds_read_b64_tr_b16 a[244:245], v7 offset:32
  ds_read_b64_tr_b16 a[246:247], v7 offset:928
  ds_write_b32 v58, a152 offset:3072
  ds_write_b32 v58, a153 offset:3328
  s_waitcnt lgkmcnt(15)
  v_mfma_f32_32x32x16_bf16 v[144:159], a[216:219], a[108:111], v[144:159]
  ds_read_b64_tr_b16 a[200:201], v8 offset:32
  ds_read_b64_tr_b16 a[202:203], v8 offset:928
  v_mfma_f32_32x32x16_bf16 v[144:159], a[220:223], a[116:119], v[144:159]
  ds_read_b64_tr_b16 a[204:205], v9 offset:32
  ds_read_b64_tr_b16 a[206:207], v9 offset:928
  s_waitcnt lgkmcnt(4)
  s_barrier
  s_add_u32 s35, s39, 0
  s_and_b32 s35, s35, 3
  s_lshl_b32 s38, s32, 2
  s_add_u32 s35, s35, s38
  s_and_b32 s38, s35, 1
  s_lshr_b32 s35, s35, 1
  s_cmp_eq_u32 s38, 0
  s_cselect_b32 s28, s12, s24
  s_cselect_b32 s29, s13, s25
  s_lshl_b32 s41, s37, 16
  s_lshl_b32 s3, s35, 7
  s_add_u32 s3, s3, s41
  s_add_u32 m0, s42, 0
  s_add_u32 s44, s3, 0
  buffer_load_dwordx4 v17, s[28:31], s44 offen lds
  v_mfma_f32_32x32x16_bf16 v[144:159], a[224:227], a[120:123], v[144:159]
  ds_read_b64_tr_b16 a[208:209], v3 offset:64
  ds_read_b64_tr_b16 a[210:211], v3 offset:960
  buffer_load_dwordx4 v18, s[28:31], s44 offen offset:1024 lds
  s_waitcnt vmcnt(2)
  buffer_store_dword v38, v33, s[20:23], 0 offen offset:0 sc1
  ds_read_b128 v[100:103], v59 offset:0
  ds_read_b128 v[104:107], v59 offset:512
  v_mfma_f32_32x32x16_bf16 v[144:159], a[228:231], a[124:127], v[144:159]
  ds_read_b64_tr_b16 a[212:213], v4 offset:64
  ds_read_b64_tr_b16 a[214:215], v4 offset:960
  s_add_u32 m0, s42, 2048
  s_add_u32 s44, s3, 16384
  buffer_load_dwordx4 v17, s[28:31], s44 offen lds
  s_waitcnt lgkmcnt(3)
  v_add_f32 v100, v100, v101
  v_add_f32 v102, v102, v103
  v_add_f32_e64 v100, v100, v102
  v_cvt_pk_bf16_f32 v101, v100, v100
  v_lshlrev_b32_e64 v101, 16, v101
  v_sub_f32 v102, v100, v101
  v_cvt_pk_bf16_f32 v64, v101, v102
  s_nop 1
  v_mfma_f32_32x32x16_bf16 v[144:159], v[64:67], v[60:63], v[144:159]
  ds_read_b128 v[100:103], v59 offset:1024
  s_waitcnt lgkmcnt(3)
  v_add_f32 v104, v104, v105
  v_add_f32 v106, v106, v107
  v_add_f32 v104, v104, v106
  v_cvt_pk_bf16_f32 v105, v104, v104
  v_lshlrev_b32 v105, 16, v105
  v_sub_f32 v106, v104, v105
  v_cvt_pk_bf16_f32 v64, v105, v106
  ds_read_b128 v[104:107], v59 offset:1536
  s_nop 1
  v_mul_f32 v80, v144, v54
  v_mfma_f32_32x32x16_bf16 v[160:175], a[232:235], a[100:103], v[160:175]
  ds_read_b64_tr_b16 a[216:217], v5 offset:64
  ds_read_b64_tr_b16 a[218:219], v5 offset:960
  buffer_load_dwordx4 v18, s[28:31], s44 offen offset:1024 lds
  v_mul_f32 v81, v145, v54
  v_mul_f32 v82, v146, v54
  v_mul_f32 v83, v147, v54
  v_mul_f32 v84, v148, v54
  v_mul_f32 v85, v149, v54
  v_mul_f32 v86, v150, v54
  v_mul_f32_e64 v87, v151, v54
  v_mfma_f32_32x32x16_bf16 v[160:175], a[236:239], a[104:107], v[160:175]
  ds_read_b64_tr_b16 a[220:221], v7 offset:64
  ds_read_b64_tr_b16 a[222:223], v7 offset:960
  s_add_u32 m0, s42, 4096
  s_add_u32 s44, s3, 32768
  buffer_load_dwordx4 v17, s[28:31], s44 offen lds
  v_exp_f32 v80, v80
  v_mul_f32 v144, v144, v152
  v_exp_f32_e64 v81, v81
  v_mfma_f32_32x32x16_bf16 v[160:175], a[240:243], a[108:111], v[160:175]
  ds_read_b64_tr_b16 a[224:225], v8 offset:64
  ds_read_b64_tr_b16 a[226:227], v8 offset:960
  buffer_load_dwordx4 v18, s[28:31], s44 offen offset:1024 lds
  v_mul_f32 v145, v145, v153
  v_exp_f32 v82, v82
  v_mul_f32 v146, v146, v154
  v_exp_f32 v83, v83
  v_mul_f32_e64 v147, v147, v155
  v_mfma_f32_32x32x16_bf16 v[160:175], a[244:247], a[116:119], v[160:175]
  ds_read_b64_tr_b16 a[228:229], v9 offset:64
  ds_read_b64_tr_b16 a[230:231], v9 offset:960
  s_add_u32 m0, s42, 6144
  s_add_u32 s44, s3, 49152
  buffer_load_dwordx4 v17, s[28:31], s44 offen lds
  s_waitcnt lgkmcnt(10)
  v_exp_f32 v84, v84
  v_mul_f32 v148, v148, v156
  v_exp_f32 v85, v85
  v_mfma_f32_32x32x16_bf16 v[160:175], a[200:203], a[120:123], v[160:175]
  ds_read_b64_tr_b16 a[232:233], v3 offset:96
  ds_read_b64_tr_b16 a[234:235], v3 offset:992
  buffer_load_dwordx4 v18, s[28:31], s44 offen offset:1024 lds
  v_mul_f32 v149, v149, v157
  v_exp_f32 v86, v86
  v_mul_f32 v150, v150, v158
  v_exp_f32 v87, v87
  v_mul_f32 v151, v151, v159
  v_mfma_f32_32x32x16_bf16 v[160:175], a[204:207], a[124:127], v[160:175]
  ds_read_b64_tr_b16 a[236:237], v4 offset:96
  ds_read_b64_tr_b16 a[238:239], v4 offset:992
  s_add_u32 s35, s39, 1
  s_and_b32 s35, s35, 3
  s_lshl_b32 s38, s32, 2
  s_add_u32 s35, s35, s38
  s_and_b32 s38, s35, 1
  s_lshr_b32 s35, s35, 1
  s_cmp_eq_u32 s38, 0
  s_cselect_b32 s28, s12, s24
  s_cselect_b32 s29, s13, s25
  s_lshl_b32 s41, s37, 16
  s_lshl_b32 s3, s35, 7
  s_add_u32 s3, s3, s41
  s_add_u32 m0, s42, 8192
  s_add_u32 s44, s3, 0
  buffer_load_dwordx4 v17, s[28:31], s44 offen lds
  v_mfma_f32_32x32x16_bf16 v[160:175], v[64:67], v[60:63], v[160:175]
  v_fma_f32 v80, v80, v55, v55
  v_fma_f32 v81, v81, v55, v55
  v_fma_f32 v82, v82, v55, v55
  v_fma_f32 v83, v83, v55, v55
  v_fma_f32 v84, v84, v55, v55
  v_fma_f32 v85, v85, v55, v55
  v_fma_f32 v86, v86, v55, v55
  v_fma_f32 v87, v87, v55, v55
  v_rcp_f32_e64 v80, v80
  v_mfma_f32_32x32x16_bf16 v[176:191], a[208:211], a[100:103], v[176:191]
  ds_read_b64_tr_b16 a[240:241], v5 offset:96
  ds_read_b64_tr_b16 a[242:243], v5 offset:992
  buffer_load_dwordx4 v18, s[28:31], s44 offen offset:1024 lds
  v_rcp_f32 v81, v81
  v_rcp_f32 v82, v82
  v_rcp_f32 v83, v83
  v_rcp_f32 v84, v84
  v_mfma_f32_32x32x16_bf16 v[176:191], a[212:215], a[104:107], v[176:191]
  ds_read_b64_tr_b16 a[244:245], v7 offset:96
  ds_read_b64_tr_b16 a[246:247], v7 offset:992
  s_add_u32 m0, s42, 10240
  s_add_u32 s44, s3, 16384
  buffer_load_dwordx4 v17, s[28:31], s44 offen lds
  s_waitcnt lgkmcnt(8)
  v_rcp_f32 v85, v85
  v_rcp_f32_e64 v86, v86
  v_mfma_f32_32x32x16_bf16 v[176:191], a[216:219], a[108:111], v[176:191]
  ds_read_b64_tr_b16 a[200:201], v8 offset:96
  ds_read_b64_tr_b16 a[202:203], v8 offset:992
  buffer_load_dwordx4 v18, s[28:31], s44 offen offset:1024 lds
  v_rcp_f32 v87, v87
  v_mul_f32 v144, v144, v80
  v_mul_f32 v145, v145, v81
  v_mul_f32 v146, v146, v82
  v_mul_f32 v147, v147, v83
  v_mul_f32 v148, v148, v84
  v_mfma_f32_32x32x16_bf16 v[176:191], a[220:223], a[116:119], v[176:191]
  ds_read_b64_tr_b16 a[204:205], v9 offset:96
  ds_read_b64_tr_b16 a[206:207], v9 offset:992
  s_add_u32 m0, s42, 12288
  s_add_u32 s44, s3, 32768
  buffer_load_dwordx4 v17, s[28:31], s44 offen lds
  v_mul_f32 v149, v149, v85
  v_mul_f32 v150, v150, v86
  v_mul_f32_e64 v151, v151, v87
  v_cvt_pk_bf16_f32 v88, v144, v145
  v_cvt_pk_bf16_f32 v89, v146, v147
  v_mfma_f32_32x32x16_bf16 v[176:191], a[224:227], a[120:123], v[176:191]
  ds_read_b64_tr_b16 a[208:209], v3 offset:128
  ds_read_b64_tr_b16 a[210:211], v3 offset:1024
  buffer_load_dwordx4 v18, s[28:31], s44 offen offset:1024 lds
  v_cvt_pk_bf16_f32 v90, v148, v149
  v_cvt_pk_bf16_f32 v91, v150, v151
  s_add_u32 s46, s92, 0
  buffer_store_dwordx4 v[88:91], v15, s[20:23], s46 offen sc1
  v_add_f32 v100, v100, v101
  v_add_f32 v102, v102, v103
  v_add_f32 v100, v100, v102
  v_mfma_f32_32x32x16_bf16 v[176:191], a[228:231], a[124:127], v[176:191]
  ds_read_b64_tr_b16 a[212:213], v4 offset:128
  ds_read_b64_tr_b16 a[214:215], v4 offset:1024
  s_add_u32 m0, s42, 14336
  s_add_u32 s44, s3, 49152
  buffer_load_dwordx4 v17, s[28:31], s44 offen lds
  s_waitcnt lgkmcnt(8)
  v_cvt_pk_bf16_f32 v101, v100, v100
  v_lshlrev_b32 v101, 16, v101
  v_sub_f32 v102, v100, v101
  v_cvt_pk_bf16_f32 v64, v101, v102
  s_nop 1
  v_mfma_f32_32x32x16_bf16 v[176:191], v[64:67], v[60:63], v[176:191]
  ds_read_b128 v[100:103], v59 offset:2048
  v_mul_f32 v80, v160, v54
  v_mul_f32 v81, v161, v54
  v_mul_f32 v82, v162, v54
  v_mul_f32 v83, v163, v54
  v_mul_f32 v84, v164, v54
  v_mul_f32 v85, v165, v54
  v_mul_f32 v86, v166, v54
  v_mul_f32 v87, v167, v54
  v_exp_f32_e64 v80, v80
  v_mfma_f32_32x32x16_bf16 v[192:207], a[232:235], a[100:103], v[192:207]
  ds_read_b64_tr_b16 a[216:217], v5 offset:128
  ds_read_b64_tr_b16 a[218:219], v5 offset:1024
  buffer_load_dwordx4 v18, s[28:31], s44 offen offset:1024 lds
  v_mul_f32 v160, v160, v168
  v_exp_f32 v81, v81
  v_mul_f32 v161, v161, v169
  v_exp_f32 v82, v82
  v_mul_f32 v162, v162, v170
  v_mfma_f32_32x32x16_bf16 v[192:207], a[236:239], a[104:107], v[192:207]
  ds_read_b64_tr_b16 a[220:221], v7 offset:128
  ds_read_b64_tr_b16 a[222:223], v7 offset:1024
  s_add_u32 s35, s39, 2
  s_and_b32 s35, s35, 3
  s_lshl_b32 s38, s32, 2
  s_add_u32 s35, s35, s38
  s_and_b32 s38, s35, 1
  s_lshr_b32 s35, s35, 1
  s_cmp_eq_u32 s38, 0
  s_cselect_b32 s28, s12, s24
  s_cselect_b32 s29, s13, s25
  s_lshl_b32 s41, s37, 16
  s_lshl_b32 s3, s35, 7
  s_add_u32 s3, s3, s41
  s_add_u32 m0, s42, 16384
  s_add_u32 s44, s3, 0
  buffer_load_dwordx4 v17, s[28:31], s44 offen lds
  v_mfma_f32_32x32x16_bf16 v[192:207], a[240:243], a[108:111], v[192:207]
  ds_read_b64_tr_b16 a[224:225], v8 offset:128
  ds_read_b64_tr_b16 a[226:227], v8 offset:1024
  buffer_load_dwordx4 v18, s[28:31], s44 offen offset:1024 lds
  v_exp_f32 v83, v83
  v_mul_f32 v163, v163, v171
  v_exp_f32 v84, v84
  v_mul_f32 v164, v164, v172
  v_exp_f32_e64 v85, v85
  v_mfma_f32_32x32x16_bf16 v[192:207], a[244:247], a[116:119], v[192:207]
  ds_read_b64_tr_b16 a[228:229], v9 offset:128
  ds_read_b64_tr_b16 a[230:231], v9 offset:1024
  s_add_u32 m0, s42, 18432
  s_add_u32 s44, s3, 16384
  buffer_load_dwordx4 v17, s[28:31], s44 offen lds
  s_waitcnt lgkmcnt(9)
  v_mul_f32 v165, v165, v173
  v_exp_f32 v86, v86
  v_mul_f32 v166, v166, v174
  v_mfma_f32_32x32x16_bf16 v[192:207], a[200:203], a[120:123], v[192:207]
  ds_read_b64_tr_b16 a[232:233], v3 offset:160
  ds_read_b64_tr_b16 a[234:235], v3 offset:1056
  buffer_load_dwordx4 v18, s[28:31], s44 offen offset:1024 lds
  v_exp_f32 v87, v87
  v_mul_f32 v167, v167, v175
  v_fma_f32 v80, v80, v55, v55
  v_fma_f32 v81, v81, v55, v55
  v_fma_f32 v82, v82, v55, v55
  v_fma_f32 v83, v83, v55, v55
  v_mfma_f32_32x32x16_bf16 v[192:207], a[204:207], a[124:127], v[192:207]
  ds_read_b64_tr_b16 a[236:237], v4 offset:160
  ds_read_b64_tr_b16 a[238:239], v4 offset:1056
  s_add_u32 m0, s42, 20480
  s_add_u32 s44, s3, 32768
  buffer_load_dwordx4 v17, s[28:31], s44 offen lds
  v_fma_f32 v84, v84, v55, v55
  v_fma_f32 v85, v85, v55, v55
  v_fma_f32 v86, v86, v55, v55
  v_fma_f32 v87, v87, v55, v55
  v_rcp_f32 v80, v80
  v_rcp_f32 v81, v81
  v_rcp_f32 v82, v82
  v_rcp_f32 v83, v83
  v_rcp_f32 v84, v84
  v_rcp_f32 v85, v85
  v_rcp_f32 v86, v86
  v_rcp_f32 v87, v87
  v_mul_f32 v160, v160, v80
  v_mul_f32 v161, v161, v81
  v_mul_f32 v162, v162, v82
  v_mul_f32 v163, v163, v83
  v_mul_f32 v164, v164, v84
  v_mul_f32 v165, v165, v85
  v_mul_f32 v166, v166, v86
  v_mul_f32 v167, v167, v87
  v_cvt_pk_bf16_f32 v92, v160, v161
  v_cvt_pk_bf16_f32 v93, v162, v163
  v_cvt_pk_bf16_f32 v94, v164, v165
  v_cvt_pk_bf16_f32 v95, v166, v167
  s_add_u32 s46, s92, 1024
  buffer_store_dwordx4 v[92:95], v15, s[20:23], s46 offen sc1
  v_add_f32 v104, v104, v105
  v_add_f32 v106, v106, v107
  v_add_f32_e64 v104, v104, v106
  v_cvt_pk_bf16_f32 v105, v104, v104
  v_lshlrev_b32_e64 v105, 16, v105
  v_sub_f32 v106, v104, v105
  v_cvt_pk_bf16_f32 v64, v105, v106
  s_nop 1
  v_mfma_f32_32x32x16_bf16 v[192:207], v[64:67], v[60:63], v[192:207]
  ds_read_b128 v[104:107], v59 offset:2560
  v_mul_f32 v80, v176, v54
  v_mul_f32 v81, v177, v54
  v_mul_f32 v82, v178, v54
  v_mul_f32 v83, v179, v54
  v_mul_f32 v84, v180, v54
  v_mul_f32 v85, v181, v54
  v_mul_f32 v86, v182, v54
  v_mul_f32 v87, v183, v54
  v_exp_f32_e64 v80, v80
  v_mfma_f32_32x32x16_bf16 v[208:223], a[208:211], a[100:103], v[208:223]
  ds_read_b64_tr_b16 a[240:241], v5 offset:160
  ds_read_b64_tr_b16 a[242:243], v5 offset:1056
  buffer_load_dwordx4 v18, s[28:31], s44 offen offset:1024 lds
  v_mul_f32 v176, v176, v184
  v_exp_f32 v81, v81
  v_mul_f32 v177, v177, v185
  v_exp_f32 v82, v82
  v_mul_f32_e64 v178, v178, v186
  v_mfma_f32_32x32x16_bf16 v[208:223], a[212:215], a[104:107], v[208:223]
  ds_read_b64_tr_b16 a[244:245], v7 offset:160
  ds_read_b64_tr_b16 a[246:247], v7 offset:1056
  s_add_u32 m0, s42, 22528
  s_add_u32 s44, s3, 49152
  buffer_load_dwordx4 v17, s[28:31], s44 offen lds
  s_waitcnt lgkmcnt(9)
  v_exp_f32 v83, v83
  v_mul_f32 v179, v179, v187
  v_exp_f32 v84, v84
  v_mfma_f32_32x32x16_bf16 v[208:223], a[216:219], a[108:111], v[208:223]
  ds_read_b64_tr_b16 a[200:201], v8 offset:160
  ds_read_b64_tr_b16 a[202:203], v8 offset:1056
  buffer_load_dwordx4 v18, s[28:31], s44 offen offset:1024 lds
  buffer_load_dword v32, v31, s[20:23], 0 offen offset:0 sc1
  v_mul_f32 v180, v180, v188
  v_exp_f32 v85, v85
  v_mul_f32 v181, v181, v189
  v_exp_f32 v86, v86
  v_mfma_f32_32x32x16_bf16 v[208:223], a[220:223], a[116:119], v[208:223]
  ds_read_b64_tr_b16 a[204:205], v9 offset:160
  ds_read_b64_tr_b16 a[206:207], v9 offset:1056
  v_mul_f32 v182, v182, v190
  v_exp_f32 v87, v87
  v_mul_f32_e64 v183, v183, v191
  v_fma_f32 v80, v80, v55, v55
  v_fma_f32 v81, v81, v55, v55
  v_fma_f32 v82, v82, v55, v55
  v_fma_f32 v83, v83, v55, v55
  v_mfma_f32_32x32x16_bf16 v[208:223], a[224:227], a[120:123], v[208:223]
  ds_read_b64_tr_b16 a[208:209], v3 offset:192
  ds_read_b64_tr_b16 a[210:211], v3 offset:1088
  v_fma_f32 v84, v84, v55, v55
  v_fma_f32 v85, v85, v55, v55
  v_fma_f32 v86, v86, v55, v55
  v_fma_f32 v87, v87, v55, v55
  v_rcp_f32 v80, v80
  v_rcp_f32 v81, v81
  v_mfma_f32_32x32x16_bf16 v[208:223], a[228:231], a[124:127], v[208:223]
  ds_read_b64_tr_b16 a[212:213], v4 offset:192
  ds_read_b64_tr_b16 a[214:215], v4 offset:1088
  s_waitcnt lgkmcnt(8)
  v_rcp_f32 v82, v82
  v_rcp_f32 v83, v83
  v_rcp_f32 v84, v84
  v_rcp_f32 v85, v85
  v_rcp_f32 v86, v86
  v_rcp_f32 v87, v87
  v_mul_f32 v176, v176, v80
  v_mul_f32 v177, v177, v81
  v_mul_f32 v178, v178, v82
  v_mul_f32 v179, v179, v83
  v_mul_f32 v180, v180, v84
  v_mul_f32 v181, v181, v85
  v_mul_f32 v182, v182, v86
  v_mul_f32_e64 v183, v183, v87
  v_cvt_pk_bf16_f32 v88, v176, v177
  v_cvt_pk_bf16_f32 v89, v178, v179
  v_cvt_pk_bf16_f32 v90, v180, v181
  v_cvt_pk_bf16_f32 v91, v182, v183
  s_add_u32 s46, s92, 2048
  buffer_store_dwordx4 v[88:91], v15, s[20:23], s46 offen sc1
  v_add_f32 v100, v100, v101
  v_add_f32 v102, v102, v103
  v_add_f32_e64 v100, v100, v102
  v_cvt_pk_bf16_f32 v101, v100, v100
  v_lshlrev_b32_e64 v101, 16, v101
  v_sub_f32 v102, v100, v101
  v_cvt_pk_bf16_f32 v64, v101, v102
  s_nop 1
  v_mfma_f32_32x32x16_bf16 v[208:223], v[64:67], v[60:63], v[208:223]
  ds_read_b128 v[100:103], v59 offset:3072
  v_mul_f32 v80, v192, v54
  v_mul_f32 v81, v193, v54
  v_mul_f32 v82, v194, v54
  v_mul_f32 v83, v195, v54
  v_mul_f32 v84, v196, v54
  v_mul_f32 v85, v197, v54
  v_mul_f32 v86, v198, v54
  v_mul_f32 v87, v199, v54
  v_exp_f32_e64 v80, v80
  v_mfma_f32_32x32x16_bf16 v[224:239], a[232:235], a[100:103], v[224:239]
  ds_read_b64_tr_b16 a[216:217], v5 offset:192
  ds_read_b64_tr_b16 a[218:219], v5 offset:1088
  v_mul_f32 v192, v192, v200
  v_exp_f32 v81, v81
  v_mul_f32 v193, v193, v201
  v_exp_f32 v82, v82
  v_mul_f32 v194, v194, v202
  v_exp_f32 v83, v83
  v_mfma_f32_32x32x16_bf16 v[224:239], a[236:239], a[104:107], v[224:239]
  ds_read_b64_tr_b16 a[220:221], v7 offset:192
  ds_read_b64_tr_b16 a[222:223], v7 offset:1088
  v_mul_f32 v195, v195, v203
  v_exp_f32 v84, v84
  v_mul_f32 v196, v196, v204
  v_exp_f32 v85, v85
  v_mul_f32 v197, v197, v205
  v_exp_f32 v86, v86
  v_mfma_f32_32x32x16_bf16 v[224:239], a[240:243], a[108:111], v[224:239]
  ds_read_b64_tr_b16 a[224:225], v8 offset:192
  ds_read_b64_tr_b16 a[226:227], v8 offset:1088
  v_mul_f32 v198, v198, v206
  v_exp_f32 v87, v87
  v_mul_f32_e64 v199, v199, v207
  v_fma_f32 v80, v80, v55, v55
  v_fma_f32 v81, v81, v55, v55
  v_fma_f32 v82, v82, v55, v55
  v_fma_f32 v83, v83, v55, v55
  v_mfma_f32_32x32x16_bf16 v[224:239], a[244:247], a[116:119], v[224:239]
  ds_read_b64_tr_b16 a[228:229], v9 offset:192
  ds_read_b64_tr_b16 a[230:231], v9 offset:1088
  s_waitcnt lgkmcnt(9)
  v_fma_f32 v84, v84, v55, v55
  v_fma_f32 v85, v85, v55, v55
  v_fma_f32 v86, v86, v55, v55
  v_fma_f32 v87, v87, v55, v55
  v_rcp_f32 v80, v80
  v_rcp_f32_e64 v81, v81
  v_mfma_f32_32x32x16_bf16 v[224:239], a[200:203], a[120:123], v[224:239]
  v_rcp_f32 v82, v82
  v_rcp_f32 v83, v83
  v_rcp_f32 v84, v84
  v_rcp_f32 v85, v85
  v_rcp_f32_e64 v86, v86
  v_mfma_f32_32x32x16_bf16 v[224:239], a[204:207], a[124:127], v[224:239]
  v_rcp_f32 v87, v87
  v_mul_f32 v192, v192, v80
  v_mul_f32 v193, v193, v81
  v_mul_f32 v194, v194, v82
  v_mul_f32 v195, v195, v83
  v_mul_f32 v196, v196, v84
  v_mul_f32 v197, v197, v85
  v_mul_f32 v198, v198, v86
  v_mul_f32_e64 v199, v199, v87
  v_cvt_pk_bf16_f32 v92, v192, v193
  v_cvt_pk_bf16_f32 v93, v194, v195
  v_cvt_pk_bf16_f32 v94, v196, v197
  v_cvt_pk_bf16_f32 v95, v198, v199
  s_add_u32 s46, s92, 3072
  buffer_store_dwordx4 v[92:95], v15, s[20:23], s46 offen sc1
  v_add_f32 v104, v104, v105
  v_add_f32 v106, v106, v107
  v_add_f32_e64 v104, v104, v106
  v_cvt_pk_bf16_f32 v105, v104, v104
  v_lshlrev_b32 v105, 16, v105
  v_sub_f32 v106, v104, v105
  v_cvt_pk_bf16_f32 v64, v105, v106
  s_nop 1
  v_mfma_f32_32x32x16_bf16 v[224:239], v[64:67], v[60:63], v[224:239]
  v_mul_f32 v80, v208, v54
  v_mul_f32 v81, v209, v54
  v_mul_f32 v82, v210, v54
  v_mul_f32 v83, v211, v54
  v_mul_f32 v84, v212, v54
  v_mul_f32 v85, v213, v54
  v_mul_f32 v86, v214, v54
  v_mul_f32 v87, v215, v54
  v_exp_f32 v80, v80
  v_mfma_f32_32x32x16_bf16 v[240:255], a[208:211], a[100:103], v[240:255]
F_HBACK:
  s_waitcnt vmcnt(2)
  v_cmp_ne_u32 vcc, s50, v32
  s_nop 3
  s_cbranch_vccnz F_HSPIN
  v_mul_f32 v208, v208, v216
  v_exp_f32 v81, v81
  v_mul_f32 v209, v209, v217
  v_exp_f32 v82, v82
  v_mul_f32 v210, v210, v218
  v_exp_f32 v83, v83
  v_mfma_f32_32x32x16_bf16 v[240:255], a[212:215], a[104:107], v[240:255]
  s_add_u32 s35, s39, 0
  s_and_b32 s35, s35, 3
  s_lshl_b32 s38, s32, 2
  s_add_u32 s35, s35, s38
  s_and_b32 s38, s35, 1
  s_lshr_b32 s35, s35, 1
  s_lshl_b32 s101, s35, 13
  s_lshl_b32 s38, s38, 11
  s_add_u32 s101, s101, s38
  s_add_u32 s101, s101, s97
  s_add_u32 s51, s101, 0
  buffer_load_dwordx4 a[0:3], v15, s[20:23], s51 offen sc1
  s_add_u32 s51, s101, 65536
  buffer_load_dwordx4 a[4:7], v15, s[20:23], s51 offen sc1
  s_waitcnt lgkmcnt(0)
  v_mfma_f32_32x32x16_bf16 v[240:255], a[216:219], a[108:111], v[240:255]
  s_add_u32 s51, s101, 1024
  buffer_load_dwordx4 a[8:11], v15, s[20:23], s51 offen sc1
  s_add_u32 s51, s101, 66560
  buffer_load_dwordx4 a[12:15], v15, s[20:23], s51 offen sc1
  v_mul_f32 v211, v211, v219
  v_exp_f32 v84, v84
  v_mul_f32 v212, v212, v220
  v_exp_f32 v85, v85
  v_mfma_f32_32x32x16_bf16 v[240:255], a[220:223], a[116:119], v[240:255]
  s_add_u32 s51, s101, 4096
  buffer_load_dwordx4 a[16:19], v15, s[20:23], s51 offen sc1
  s_add_u32 s51, s101, 69632
  buffer_load_dwordx4 a[20:23], v15, s[20:23], s51 offen sc1
  v_mul_f32 v213, v213, v221
  v_exp_f32 v86, v86
  v_mul_f32 v214, v214, v222
  v_exp_f32 v87, v87
  v_mfma_f32_32x32x16_bf16 v[240:255], a[224:227], a[120:123], v[240:255]
  s_add_u32 s51, s101, 5120
  buffer_load_dwordx4 a[24:27], v15, s[20:23], s51 offen sc1
  s_add_u32 s51, s101, 70656
  buffer_load_dwordx4 a[28:31], v15, s[20:23], s51 offen sc1
  v_mul_f32 v215, v215, v223
  v_fma_f32 v80, v80, v55, v55
  v_fma_f32 v81, v81, v55, v55
  v_fma_f32 v82, v82, v55, v55
  v_fma_f32 v83, v83, v55, v55
  v_fma_f32 v84, v84, v55, v55
  v_mfma_f32_32x32x16_bf16 v[240:255], a[228:231], a[124:127], v[240:255]
  s_add_u32 s35, s39, 1
  s_and_b32 s35, s35, 3
  s_lshl_b32 s38, s32, 2
  s_add_u32 s35, s35, s38
  s_and_b32 s38, s35, 1
  s_lshr_b32 s35, s35, 1
  s_lshl_b32 s101, s35, 13
  s_lshl_b32 s38, s38, 11
  s_add_u32 s101, s101, s38
  s_add_u32 s101, s101, s97
  s_add_u32 s51, s101, 0
  buffer_load_dwordx4 a[32:35], v15, s[20:23], s51 offen sc1
  s_add_u32 s51, s101, 65536
  buffer_load_dwordx4 a[36:39], v15, s[20:23], s51 offen sc1
  v_fma_f32 v85, v85, v55, v55
  v_fma_f32 v86, v86, v55, v55
  v_fma_f32 v87, v87, v55, v55
  v_rcp_f32 v80, v80
  v_rcp_f32 v81, v81
  v_rcp_f32 v82, v82
  v_rcp_f32 v83, v83
  v_rcp_f32 v84, v84
  v_rcp_f32 v85, v85
  v_rcp_f32 v86, v86
  v_rcp_f32 v87, v87
  v_mul_f32 v208, v208, v80
  v_mul_f32 v209, v209, v81
  v_mul_f32 v210, v210, v82
  v_mul_f32 v211, v211, v83
  v_mul_f32 v212, v212, v84
  v_mul_f32 v213, v213, v85
  v_mul_f32 v214, v214, v86
  v_mul_f32 v215, v215, v87
  v_cvt_pk_bf16_f32 v88, v208, v209
  v_cvt_pk_bf16_f32 v89, v210, v211
  v_cvt_pk_bf16_f32 v90, v212, v213
  v_cvt_pk_bf16_f32 v91, v214, v215
  s_add_u32 s46, s92, 4096
  buffer_store_dwordx4 v[88:91], v15, s[20:23], s46 offen sc1
  v_add_f32 v100, v100, v101
  v_add_f32 v102, v102, v103
  v_add_f32_e64 v100, v100, v102
  v_cvt_pk_bf16_f32 v101, v100, v100
  v_lshlrev_b32 v101, 16, v101
  v_sub_f32 v102, v100, v101
  v_cvt_pk_bf16_f32 v64, v101, v102
  s_nop 1
  v_mfma_f32_32x32x16_bf16 v[240:255], v[64:67], v[60:63], v[240:255]
  v_mul_f32 v80, v224, v54
  v_mul_f32 v81, v225, v54
  v_mul_f32 v82, v226, v54
  v_mul_f32 v83, v227, v54
  v_mul_f32 v84, v228, v54
  v_mul_f32 v85, v229, v54
  v_mul_f32 v86, v230, v54
  v_mul_f32 v87, v231, v54
  v_exp_f32 v80, v80
  v_mul_f32 v224, v224, v232
  v_exp_f32 v81, v81
  v_mul_f32 v225, v225, v233
  v_exp_f32 v82, v82
  v_mul_f32 v226, v226, v234
  v_exp_f32 v83, v83
  v_mul_f32 v227, v227, v235
  v_exp_f32 v84, v84
  v_mul_f32 v228, v228, v236
  v_exp_f32 v85, v85
  v_mul_f32 v229, v229, v237
  v_exp_f32 v86, v86
  v_mul_f32 v230, v230, v238
  v_exp_f32 v87, v87
  v_mul_f32_e64 v231, v231, v239
  v_fma_f32 v80, v80, v55, v55
  v_fma_f32 v81, v81, v55, v55
  v_fma_f32 v82, v82, v55, v55
  v_fma_f32 v83, v83, v55, v55
  v_fma_f32 v84, v84, v55, v55
  v_fma_f32 v85, v85, v55, v55
  v_fma_f32 v86, v86, v55, v55
  v_fma_f32 v87, v87, v55, v55
  v_rcp_f32 v80, v80
  v_rcp_f32 v81, v81
  v_rcp_f32 v82, v82
  v_rcp_f32 v83, v83
  v_rcp_f32 v84, v84
  v_rcp_f32 v85, v85
  v_rcp_f32 v86, v86
  v_rcp_f32 v87, v87
  v_mul_f32 v224, v224, v80
  v_mul_f32 v225, v225, v81
  v_mul_f32 v226, v226, v82
  v_mul_f32 v227, v227, v83
  v_mul_f32 v228, v228, v84
  v_mul_f32 v229, v229, v85
  v_mul_f32 v230, v230, v86
  v_mul_f32 v231, v231, v87
  v_cvt_pk_bf16_f32 v92, v224, v225
  v_cvt_pk_bf16_f32 v93, v226, v227
  v_cvt_pk_bf16_f32 v94, v228, v229
  v_cvt_pk_bf16_f32 v95, v230, v231
  s_add_u32 s46, s92, 5120
  buffer_store_dwordx4 v[92:95], v15, s[20:23], s46 offen sc1
  v_mul_f32 v80, v240, v54
  v_mul_f32 v81, v241, v54
  v_mul_f32 v82, v242, v54
  v_mul_f32 v83, v243, v54
  v_mul_f32 v84, v244, v54
  v_mul_f32 v85, v245, v54
  v_mul_f32 v86, v246, v54
  v_mul_f32 v87, v247, v54
  v_exp_f32 v80, v80
  v_mul_f32 v240, v240, v248
  v_exp_f32 v81, v81
  v_mul_f32 v241, v241, v249
  v_exp_f32 v82, v82
  v_mul_f32 v242, v242, v250
  v_exp_f32 v83, v83
  v_mul_f32 v243, v243, v251
  v_exp_f32 v84, v84
  v_mul_f32 v244, v244, v252
  v_exp_f32 v85, v85
  v_mul_f32 v245, v245, v253
  v_exp_f32 v86, v86
  v_mul_f32 v246, v246, v254
  v_exp_f32 v87, v87
  v_mul_f32 v247, v247, v255
  v_fma_f32 v80, v80, v55, v55
  v_fma_f32 v81, v81, v55, v55
  v_fma_f32 v82, v82, v55, v55
  v_fma_f32 v83, v83, v55, v55
  v_fma_f32 v84, v84, v55, v55
  v_fma_f32 v85, v85, v55, v55
  v_fma_f32 v86, v86, v55, v55
  v_fma_f32 v87, v87, v55, v55
  v_rcp_f32 v80, v80
  v_rcp_f32 v81, v81
  v_rcp_f32 v82, v82
  v_rcp_f32 v83, v83
  v_rcp_f32 v84, v84
  v_rcp_f32 v85, v85
  v_rcp_f32 v86, v86
  v_rcp_f32 v87, v87
  v_mul_f32 v240, v240, v80
  v_mul_f32 v241, v241, v81
  v_mul_f32 v242, v242, v82
  v_mul_f32 v243, v243, v83
  v_mul_f32 v244, v244, v84
  v_mul_f32 v245, v245, v85
  v_mul_f32 v246, v246, v86
  v_mul_f32 v247, v247, v87
  v_cvt_pk_bf16_f32 v88, v240, v241
  v_cvt_pk_bf16_f32 v89, v242, v243
  v_cvt_pk_bf16_f32 v90, v244, v245
  v_cvt_pk_bf16_f32 v91, v246, v247
  s_add_u32 s46, s92, 6144
  buffer_store_dwordx4 v[88:91], v15, s[20:23], s46 offen sc1
  s_add_u32 s51, s101, 1024
  buffer_load_dwordx4 a[40:43], v15, s[20:23], s51 offen sc1
  s_add_u32 s51, s101, 66560
  buffer_load_dwordx4 a[44:47], v15, s[20:23], s51 offen sc1
  s_add_u32 s51, s101, 4096
  buffer_load_dwordx4 a[48:51], v15, s[20:23], s51 offen sc1
  s_add_u32 s51, s101, 69632
  buffer_load_dwordx4 a[52:55], v15, s[20:23], s51 offen sc1
  s_add_u32 s51, s101, 5120
  buffer_load_dwordx4 a[56:59], v15, s[20:23], s51 offen sc1
  s_add_u32 s51, s101, 70656
  buffer_load_dwordx4 a[60:63], v15, s[20:23], s51 offen sc1
  s_add_u32 s35, s39, 2
  s_and_b32 s35, s35, 3
  s_lshl_b32 s38, s32, 2
  s_add_u32 s35, s35, s38
  s_and_b32 s38, s35, 1
  s_lshr_b32 s35, s35, 1
  s_lshl_b32 s101, s35, 13
  s_lshl_b32 s38, s38, 11
  s_add_u32 s101, s101, s38
  s_add_u32 s101, s101, s97
  s_add_u32 s51, s101, 0
  buffer_load_dwordx4 a[64:67], v15, s[20:23], s51 offen sc1
  s_add_u32 s51, s101, 65536
  buffer_load_dwordx4 a[68:71], v15, s[20:23], s51 offen sc1
  s_add_u32 s51, s101, 1024
  buffer_load_dwordx4 a[72:75], v15, s[20:23], s51 offen sc1
  s_add_u32 s51, s101, 66560
  buffer_load_dwordx4 a[76:79], v15, s[20:23], s51 offen sc1
  s_add_u32 s51, s101, 4096
  buffer_load_dwordx4 a[80:83], v15, s[20:23], s51 offen sc1
  s_add_u32 s51, s101, 69632
  buffer_load_dwordx4 a[84:87], v15, s[20:23], s51 offen sc1
  s_add_u32 s51, s101, 5120
  buffer_load_dwordx4 a[88:91], v15, s[20:23], s51 offen sc1
  s_add_u32 s51, s101, 70656
  buffer_load_dwordx4 a[92:95], v15, s[20:23], s51 offen sc1
  buffer_store_dword v38, v33, s[20:23], 0 offen offset:256 sc1
  s_barrier
  s_mov_b32 s16, s76
  s_mov_b32 s17, s77
  s_mov_b32 s18, 1835008
  s_mov_b32 s19, 0x20000
  s_mov_b32 s4, s78
  s_mov_b32 s5, s79
  s_mov_b32 s6, 4194304
  s_mov_b32 s7, 0x20000
  v_and_b32 v198, 31, v1
  v_lshrrev_b32 v199, 5, v1
  v_bfe_u32 v201, v198, 2, 1
  v_lshlrev_b32 v201, 4, v201
  v_lshrrev_b32 v202, 3, v198
  v_lshl_add_u32 v201, v202, 2, v201
  v_and_b32 v202, 3, v198
  v_add_u32 v201, v201, v202
  v_lshlrev_b32 v201, 8, v201
  v_and_b32 v202, 7, v198
  v_xor_b32 v202, v202, v199
  s_lshl_b32 s35, s32, 14
  v_xor_b32_e64 v203, 0, v202
  v_lshl_add_u32 v204, v203, 4, v201
  v_add_u32 v40, s35, v204
  v_xor_b32 v203, 2, v202
  v_lshl_add_u32 v205, v203, 4, v201
  v_add_u32 v41, s35, v205
  v_xor_b32 v203, 4, v202
  v_lshl_add_u32 v206, v203, 4, v201
  v_add_u32 v42, s35, v206
  v_xor_b32 v203, 6, v202
  v_lshl_add_u32 v207, v203, 4, v201
  v_add_u32 v43, s35, v207
  v_and_b32 v212, 31, v1
  v_lshrrev_b32_e64 v213, 5, v1
  v_bfe_u32 v214, v212, 1, 3
  v_xor_b32 v214, v214, v213
  v_lshlrev_b32 v215, 7, v212
  v_xor_b32_e64 v216, 0, v214
  v_lshl_add_u32 v216, v216, 4, v215
  v_add_u32 v23, s42, v216
  v_xor_b32 v216, 2, v214
  v_lshl_add_u32 v216, v216, 4, v215
  v_add_u32 v24, s42, v216
  v_xor_b32 v216, 4, v214
  v_lshl_add_u32 v216, v216, 4, v215
  v_add_u32 v25, s42, v216
  v_xor_b32 v216, 6, v214
  v_lshl_add_u32 v216, v216, 4, v215
  v_add_u32 v26, s42, v216
  v_lshrrev_b32 v212, 4, v1
  v_and_b32 v213, 1, v212
  v_lshrrev_b32 v214, 1, v212
  v_bfe_u32 v215, v1, 2, 2
  v_and_b32_e64 v216, 3, v1
  v_lshl_add_u32 v214, v214, 3, v215
  v_lshlrev_b32 v214, 7, v214
  v_lshrrev_b32 v217, 1, v216
  v_lshl_add_u32 v217, v213, 1, v217
  v_bfe_u32 v215, v215, 1, 1
  v_lshl_add_u32 v217, v215, 2, v217
  v_lshl_add_u32 v214, v217, 4, v214
  v_and_b32_e64 v216, 1, v216
  v_lshl_add_u32 v214, v216, 3, v214
  v_add_u32 v19, s42, v214
  v_add_u32 v21, s43, v214
  v_xor_b32 v214, 64, v214
  v_add_u32 v20, s42, v214
  v_add_u32 v22, s43, v214
  v_lshrrev_b32 v192, 4, v1
  v_and_b32 v193, 15, v1
  s_lshl_b32 s35, s36, 6
  s_lshl_b32 s38, s32, 4
  s_add_u32 s35, s35, s38
  v_add_u32 v194, s35, v192
  s_lshl_b32 s38, s37, 7
  v_lshlrev_b32 v195, 3, v193
  v_add_u32 v125, s38, v195
  v_lshl_add_u32 v126, v194, 10, v125
  v_lshlrev_b32 v47, 1, v126
  v_lshlrev_b32 v127, 3, v194
  v_add_u32 v127, 0x40000, v127
  s_and_b32 s35, s32, 1
  s_lshl_b32 s35, s35, 2
  v_add_u32_e64 v201, s35, v192
  v_xor_b32 v201, v201, v193
  s_lshl_b32 s35, s32, 12
  v_lshl_add_u32 v202, v192, 8, s35
  v_lshl_add_u32 v44, v201, 4, v202
  v_add_u32 v45, 0x10000, v44
  v_add_u32 v46, 0x22000, v44
  v_add_u32 v120, s42, v204
  v_add_u32 v121, s42, v205
  v_add_u32 v122, s42, v206
  v_add_u32 v123, s42, v207
  s_waitcnt vmcnt(20)
  ds_read_b128 v[48:51], v23 offset:0
  ds_read_b128 v[52:55], v23 offset:4096
  s_waitcnt lgkmcnt(1)
  v_mfma_f32_32x32x16_bf16 v[128:143], v[48:51], a[0:3], 0
  ds_read_b128 v[56:59], v24 offset:0
  ds_read_b128 v[60:63], v24 offset:4096
  s_add_u32 s35, s40, 0
  s_and_b32 s35, s35, 3
  s_lshl_b32 s38, s32, 2
  s_add_u32 s35, s35, s38
  s_mul_i32 s35, s35, 7
  s_lshl_b32 s3, s35, 14
  s_lshl_b32 s41, s37, 7
  s_add_u32 s3, s3, s41
  s_add_u32 m0, s43, 0
  s_add_u32 s44, s3, 0
  buffer_load_dwordx4 v16, s[16:19], s44 offen lds
  buffer_load_dwordx4 v39, s[16:19], s44 offen offset:1024 lds
  v_mfma_f32_32x32x16_bf16 v[144:159], v[48:51], a[4:7], 0
  s_add_u32 m0, s43, 2048
  s_add_u32 s44, s3, 16384
  buffer_load_dwordx4 v16, s[16:19], s44 offen lds
  buffer_load_dwordx4 v39, s[16:19], s44 offen offset:1024 lds
  s_waitcnt lgkmcnt(2)
  v_mfma_f32_32x32x16_bf16 v[160:175], v[52:55], a[0:3], 0
  s_add_u32 s35, s39, 3
  s_and_b32 s35, s35, 3
  s_lshl_b32 s38, s32, 2
  s_add_u32 s35, s35, s38
  s_and_b32 s38, s35, 1
  s_lshr_b32 s35, s35, 1
  s_lshl_b32 s101, s35, 13
  s_lshl_b32 s38, s38, 11
  s_add_u32 s101, s101, s38
  s_add_u32 s101, s101, s97
  s_add_u32 s51, s101, 0
  buffer_load_dwordx4 a[96:99], v15, s[20:23], s51 offen sc1
  s_add_u32 s51, s101, 65536
  buffer_load_dwordx4 a[100:103], v15, s[20:23], s51 offen sc1
  v_mfma_f32_32x32x16_bf16 v[176:191], v[52:55], a[4:7], 0
  s_add_u32 s51, s101, 1024
  buffer_load_dwordx4 a[104:107], v15, s[20:23], s51 offen sc1
  s_add_u32 s51, s101, 66560
  buffer_load_dwordx4 a[108:111], v15, s[20:23], s51 offen sc1
  s_waitcnt lgkmcnt(1)
  v_mfma_f32_32x32x16_bf16 v[128:143], v[56:59], a[8:11], v[128:143]
  ds_read_b128 v[48:51], v25 offset:0
  ds_read_b128 v[52:55], v25 offset:4096
  s_add_u32 s35, s40, 1
  s_and_b32 s35, s35, 3
  s_lshl_b32 s38, s32, 2
  s_add_u32 s35, s35, s38
  s_mul_i32 s35, s35, 7
  s_lshl_b32 s3, s35, 14
  s_lshl_b32 s41, s37, 7
  s_add_u32 s3, s3, s41
  s_add_u32 m0, s43, 4096
  s_add_u32 s44, s3, 0
  buffer_load_dwordx4 v16, s[16:19], s44 offen lds
  buffer_load_dwordx4 v39, s[16:19], s44 offen offset:1024 lds
  v_mfma_f32_32x32x16_bf16 v[144:159], v[56:59], a[12:15], v[144:159]
  s_add_u32 m0, s43, 6144
  s_add_u32 s44, s3, 16384
  buffer_load_dwordx4 v16, s[16:19], s44 offen lds
  buffer_load_dwordx4 v39, s[16:19], s44 offen offset:1024 lds
  s_waitcnt lgkmcnt(2)
  v_mfma_f32_32x32x16_bf16 v[160:175], v[60:63], a[8:11], v[160:175]
  s_add_u32 s51, s101, 4096
  buffer_load_dwordx4 a[112:115], v15, s[20:23], s51 offen sc1
  s_add_u32 s51, s101, 69632
  buffer_load_dwordx4 a[116:119], v15, s[20:23], s51 offen sc1
  v_mfma_f32_32x32x16_bf16 v[176:191], v[60:63], a[12:15], v[176:191]
  s_add_u32 s51, s101, 5120
  buffer_load_dwordx4 a[120:123], v15, s[20:23], s51 offen sc1
  s_add_u32 s51, s101, 70656
  buffer_load_dwordx4 a[124:127], v15, s[20:23], s51 offen sc1
  s_waitcnt lgkmcnt(1)
  v_mfma_f32_32x32x16_bf16 v[128:143], v[48:51], a[16:19], v[128:143]
  ds_read_b128 v[56:59], v26 offset:0
  ds_read_b128 v[60:63], v26 offset:4096
  s_add_u32 s35, s40, 2
  s_and_b32 s35, s35, 3
  s_lshl_b32 s38, s32, 2
  s_add_u32 s35, s35, s38
  s_mul_i32 s35, s35, 7
  s_lshl_b32 s3, s35, 14
  s_lshl_b32 s41, s37, 7
  s_add_u32 s3, s3, s41
  s_add_u32 m0, s43, 8192
  s_add_u32 s44, s3, 0
  buffer_load_dwordx4 v16, s[16:19], s44 offen lds
  global_load_dwordx2 v[80:81], v125, s[68:69]
  buffer_load_dwordx2 v[64:65], v126, s[8:11], 0 offen
  v_add_u32 v126, 0x1000, v126
  v_mfma_f32_32x32x16_bf16 v[144:159], v[48:51], a[20:23], v[144:159]
  buffer_load_dwordx4 v39, s[16:19], s44 offen offset:1024 lds
  buffer_load_dwordx2 v[72:73], v127, s[20:23], 0 offen offset:0 sc1
  buffer_load_dwordx2 v[66:67], v126, s[8:11], 0 offen
  v_add_u32 v126, 0x1000, v126
  s_waitcnt lgkmcnt(2)
  v_mfma_f32_32x32x16_bf16 v[160:175], v[52:55], a[16:19], v[160:175]
  s_add_u32 m0, s43, 10240
  s_add_u32 s44, s3, 16384
  buffer_load_dwordx4 v16, s[16:19], s44 offen lds
  buffer_load_dwordx2 v[74:75], v127, s[20:23], 0 offen offset:32 sc1
  buffer_load_dwordx2 v[68:69], v126, s[8:11], 0 offen
  v_add_u32 v126, 0x1000, v126
  v_mfma_f32_32x32x16_bf16 v[176:191], v[52:55], a[20:23], v[176:191]
  buffer_load_dwordx4 v39, s[16:19], s44 offen offset:1024 lds
  buffer_load_dwordx2 v[76:77], v127, s[20:23], 0 offen offset:64 sc1
  buffer_load_dwordx2 v[70:71], v126, s[8:11], 0 offen
  v_add_u32 v126, 0x1000, v126
  s_waitcnt vmcnt(43)
  buffer_store_dword v38, v33, s[20:23], 0 offen offset:512 sc1
  s_waitcnt lgkmcnt(1)
  v_mfma_f32_32x32x16_bf16 v[128:143], v[56:59], a[24:27], v[128:143]
  s_waitcnt vmcnt(38)
  ds_read_b128 v[48:51], v23 offset:8192
  ds_read_b128 v[52:55], v23 offset:12288
  s_add_u32 s35, s40, 3
  s_and_b32 s35, s35, 3
  s_lshl_b32 s38, s32, 2
  s_add_u32 s35, s35, s38
  s_mul_i32 s35, s35, 7
  s_lshl_b32 s3, s35, 14
  s_lshl_b32 s41, s37, 7
  s_add_u32 s3, s3, s41
  s_add_u32 m0, s43, 12288
  s_add_u32 s44, s3, 0
  buffer_load_dwordx4 v16, s[16:19], s44 offen lds
  buffer_load_dwordx2 v[78:79], v127, s[20:23], 0 offen offset:96 sc1
  v_mfma_f32_32x32x16_bf16 v[144:159], v[56:59], a[28:31], v[144:159]
  buffer_load_dwordx4 v39, s[16:19], s44 offen offset:1024 lds
  s_waitcnt lgkmcnt(2)
  v_mfma_f32_32x32x16_bf16 v[160:175], v[60:63], a[24:27], v[160:175]
  s_add_u32 m0, s43, 14336
  s_add_u32 s44, s3, 16384
  buffer_load_dwordx4 v16, s[16:19], s44 offen lds
  v_mfma_f32_32x32x16_bf16 v[176:191], v[60:63], a[28:31], v[176:191]
  buffer_load_dwordx4 v39, s[16:19], s44 offen offset:1024 lds
  s_waitcnt lgkmcnt(1)
  v_mfma_f32_32x32x16_bf16 v[128:143], v[48:51], a[32:35], v[128:143]
  ds_read_b128 v[56:59], v24 offset:8192
  ds_read_b128 v[60:63], v24 offset:12288
  s_add_u32 s35, s39, 3
  s_and_b32 s35, s35, 3
  s_lshl_b32 s38, s32, 2
  s_add_u32 s35, s35, s38
  s_and_b32 s38, s35, 1
  s_lshr_b32 s35, s35, 1
  s_cmp_eq_u32 s38, 0
  s_cselect_b32 s28, s12, s24
  s_cselect_b32 s29, s13, s25
  s_lshl_b32 s41, s37, 16
  s_lshl_b32 s3, s35, 7
  s_add_u32 s3, s3, s41
  s_add_u32 m0, s42, 0
  s_add_u32 s44, s3, 0
  buffer_load_dwordx4 v17, s[28:31], s44 offen lds
  v_mfma_f32_32x32x16_bf16 v[144:159], v[48:51], a[36:39], v[144:159]
  buffer_load_dwordx4 v18, s[28:31], s44 offen offset:1024 lds
  s_waitcnt lgkmcnt(2)
  v_mfma_f32_32x32x16_bf16 v[160:175], v[52:55], a[32:35], v[160:175]
  s_add_u32 m0, s42, 2048
  s_add_u32 s44, s3, 16384
  buffer_load_dwordx4 v17, s[28:31], s44 offen lds
  v_mfma_f32_32x32x16_bf16 v[176:191], v[52:55], a[36:39], v[176:191]
  buffer_load_dwordx4 v18, s[28:31], s44 offen offset:1024 lds
  buffer_load_dword v32, v31, s[20:23], 0 offen offset:256 sc1
  s_waitcnt lgkmcnt(1)
  v_mfma_f32_32x32x16_bf16 v[128:143], v[56:59], a[40:43], v[128:143]
  ds_read_b128 v[48:51], v25 offset:8192
  ds_read_b128 v[52:55], v25 offset:12288
  s_add_u32 m0, s42, 4096
  s_add_u32 s44, s3, 32768
  buffer_load_dwordx4 v17, s[28:31], s44 offen lds
  v_mfma_f32_32x32x16_bf16 v[144:159], v[56:59], a[44:47], v[144:159]
  buffer_load_dwordx4 v18, s[28:31], s44 offen offset:1024 lds
  s_waitcnt lgkmcnt(2)
  v_mfma_f32_32x32x16_bf16 v[160:175], v[60:63], a[40:43], v[160:175]
  s_add_u32 m0, s42, 6144
  s_add_u32 s44, s3, 49152
  buffer_load_dwordx4 v17, s[28:31], s44 offen lds
  v_mfma_f32_32x32x16_bf16 v[176:191], v[60:63], a[44:47], v[176:191]
  buffer_load_dwordx4 v18, s[28:31], s44 offen offset:1024 lds
  s_waitcnt lgkmcnt(1)
  v_mfma_f32_32x32x16_bf16 v[128:143], v[48:51], a[48:51], v[128:143]
  ds_read_b128 v[56:59], v26 offset:8192
  ds_read_b128 v[60:63], v26 offset:12288
  v_mfma_f32_32x32x16_bf16 v[144:159], v[48:51], a[52:55], v[144:159]
  s_waitcnt lgkmcnt(2)
  v_mfma_f32_32x32x16_bf16 v[160:175], v[52:55], a[48:51], v[160:175]
  v_mfma_f32_32x32x16_bf16 v[176:191], v[52:55], a[52:55], v[176:191]
  s_waitcnt lgkmcnt(1)
  v_mfma_f32_32x32x16_bf16 v[128:143], v[56:59], a[56:59], v[128:143]
  s_waitcnt vmcnt(44)
  ds_read_b128 v[48:51], v23 offset:16384
  ds_read_b128 v[52:55], v23 offset:20480
  v_mfma_f32_32x32x16_bf16 v[144:159], v[56:59], a[60:63], v[144:159]
  s_waitcnt lgkmcnt(2)
  v_mfma_f32_32x32x16_bf16 v[160:175], v[60:63], a[56:59], v[160:175]
  v_mfma_f32_32x32x16_bf16 v[176:191], v[60:63], a[60:63], v[176:191]
F_ABACK:
  s_waitcnt vmcnt(4)
  v_cmp_ne_u32 vcc, s50, v32
  s_nop 3
  s_cbranch_vccnz F_ASPIN
  s_waitcnt lgkmcnt(1)
  v_mfma_f32_32x32x16_bf16 v[128:143], v[48:51], a[64:67], v[128:143]
  ds_read_b128 v[56:59], v24 offset:16384
  ds_read_b128 v[60:63], v24 offset:20480
  s_add_u32 s35, s40, 0
  s_and_b32 s35, s35, 3
  s_lshl_b32 s38, s32, 2
  s_add_u32 s35, s35, s38
  s_mul_i32 s35, s35, 7
  s_lshl_b32 s3, s35, 14
  s_lshl_b32 s41, s37, 7
  s_add_u32 s3, s3, s41
  s_add_u32 m0, s42, 8192
  s_add_u32 s44, s3, 32768
  buffer_load_dwordx4 v16, s[16:19], s44 offen lds
  buffer_load_dwordx4 v39, s[16:19], s44 offen offset:1024 lds
  v_mfma_f32_32x32x16_bf16 v[144:159], v[48:51], a[68:71], v[144:159]
  s_add_u32 m0, s42, 10240
  s_add_u32 s44, s3, 49152
  buffer_load_dwordx4 v16, s[16:19], s44 offen lds
  buffer_load_dwordx4 v39, s[16:19], s44 offen offset:1024 lds
  s_waitcnt lgkmcnt(2)
  v_mfma_f32_32x32x16_bf16 v[160:175], v[52:55], a[64:67], v[160:175]
  s_add_u32 m0, s42, 12288
  s_add_u32 s44, s3, 65536
  buffer_load_dwordx4 v16, s[16:19], s44 offen lds
  buffer_load_dwordx4 v39, s[16:19], s44 offen offset:1024 lds
  v_mfma_f32_32x32x16_bf16 v[176:191], v[52:55], a[68:71], v[176:191]
  s_add_u32 m0, s42, 14336
  s_add_u32 s44, s3, 81920
  buffer_load_dwordx4 v16, s[16:19], s44 offen lds
  buffer_load_dwordx4 v39, s[16:19], s44 offen offset:1024 lds
  s_add_u32 s35, s40, 0
  s_and_b32 s35, s35, 3
  s_lshl_b32 s38, s32, 2
  s_add_u32 s35, s35, s38
  s_mul_i32 s35, s35, 7
  s_lshl_b32 s101, s35, 10
  s_add_u32 s101, s101, s100
  s_add_u32 s51, s101, 0
  buffer_load_dwordx4 a[128:131], v15, s[20:23], s51 offen sc1
  s_add_u32 s51, s101, 114688
  buffer_load_dwordx4 a[132:135], v15, s[20:23], s51 offen sc1
  s_add_u32 s51, s101, 1024
  buffer_load_dwordx4 a[136:139], v15, s[20:23], s51 offen sc1
  s_add_u32 s51, s101, 115712
  buffer_load_dwordx4 a[140:143], v15, s[20:23], s51 offen sc1
  s_waitcnt lgkmcnt(1)
  v_mfma_f32_32x32x16_bf16 v[128:143], v[56:59], a[72:75], v[128:143]
  ds_read_b128 v[48:51], v25 offset:16384
  ds_read_b128 v[52:55], v25 offset:20480
  s_add_u32 s35, s40, 1
  s_and_b32 s35, s35, 3
  s_lshl_b32 s38, s32, 2
  s_add_u32 s35, s35, s38
  s_mul_i32 s35, s35, 7
  s_lshl_b32 s101, s35, 10
  s_add_u32 s101, s101, s100
  s_add_u32 s51, s101, 0
  buffer_load_dwordx4 a[144:147], v15, s[20:23], s51 offen sc1
  v_mfma_f32_32x32x16_bf16 v[144:159], v[56:59], a[76:79], v[144:159]
  s_add_u32 s51, s101, 114688
  buffer_load_dwordx4 a[148:151], v15, s[20:23], s51 offen sc1
  s_waitcnt lgkmcnt(2)
  v_mfma_f32_32x32x16_bf16 v[160:175], v[60:63], a[72:75], v[160:175]
  s_add_u32 s51, s101, 1024
  buffer_load_dwordx4 a[152:155], v15, s[20:23], s51 offen sc1
  v_mfma_f32_32x32x16_bf16 v[176:191], v[60:63], a[76:79], v[176:191]
  s_add_u32 s51, s101, 115712
  buffer_load_dwordx4 a[156:159], v15, s[20:23], s51 offen sc1
  s_waitcnt lgkmcnt(1)
  v_mfma_f32_32x32x16_bf16 v[128:143], v[48:51], a[80:83], v[128:143]
  ds_read_b128 v[56:59], v26 offset:16384
  ds_read_b128 v[60:63], v26 offset:20480
  s_add_u32 s35, s40, 2
  s_and_b32 s35, s35, 3
  s_lshl_b32 s38, s32, 2
  s_add_u32 s35, s35, s38
  s_mul_i32 s35, s35, 7
  s_lshl_b32 s101, s35, 10
  s_add_u32 s101, s101, s100
  s_add_u32 s51, s101, 0
  buffer_load_dwordx4 a[160:163], v15, s[20:23], s51 offen sc1
  v_mfma_f32_32x32x16_bf16 v[144:159], v[48:51], a[84:87], v[144:159]
  s_add_u32 s51, s101, 114688
  buffer_load_dwordx4 a[164:167], v15, s[20:23], s51 offen sc1
  s_waitcnt lgkmcnt(2)
  v_mfma_f32_32x32x16_bf16 v[160:175], v[52:55], a[80:83], v[160:175]
  s_add_u32 s51, s101, 1024
  buffer_load_dwordx4 a[168:171], v15, s[20:23], s51 offen sc1
  v_mfma_f32_32x32x16_bf16 v[176:191], v[52:55], a[84:87], v[176:191]
  s_add_u32 s51, s101, 115712
  buffer_load_dwordx4 a[172:175], v15, s[20:23], s51 offen sc1
  s_waitcnt lgkmcnt(1)
  v_mfma_f32_32x32x16_bf16 v[128:143], v[56:59], a[88:91], v[128:143]
  s_waitcnt vmcnt(20)
  ds_read_b128 v[48:51], v23 offset:0
  ds_read_b128 v[52:55], v23 offset:4096
  s_add_u32 s35, s40, 3
  s_and_b32 s35, s35, 3
  s_lshl_b32 s38, s32, 2
  s_add_u32 s35, s35, s38
  s_mul_i32 s35, s35, 7
  s_lshl_b32 s101, s35, 10
  s_add_u32 s101, s101, s100
  s_add_u32 s51, s101, 0
  buffer_load_dwordx4 a[176:179], v15, s[20:23], s51 offen sc1
  v_mfma_f32_32x32x16_bf16 v[144:159], v[56:59], a[92:95], v[144:159]
  s_add_u32 s51, s101, 114688
  buffer_load_dwordx4 a[180:183], v15, s[20:23], s51 offen sc1
  s_waitcnt lgkmcnt(2)
  v_mfma_f32_32x32x16_bf16 v[160:175], v[60:63], a[88:91], v[160:175]
  s_add_u32 s51, s101, 1024
  buffer_load_dwordx4 a[184:187], v15, s[20:23], s51 offen sc1
  v_mfma_f32_32x32x16_bf16 v[176:191], v[60:63], a[92:95], v[176:191]
  s_add_u32 s51, s101, 115712
  buffer_load_dwordx4 a[188:191], v15, s[20:23], s51 offen sc1
  s_waitcnt lgkmcnt(1)
  v_mfma_f32_32x32x16_bf16 v[128:143], v[48:51], a[96:99], v[128:143]
  ds_read_b128 v[56:59], v24 offset:0
  ds_read_b128 v[60:63], v24 offset:4096
  s_add_u32 m0, s42, 16384
  s_add_u32 s44, s3, 98304
  buffer_load_dwordx4 v16, s[16:19], s44 offen lds
  buffer_load_dwordx4 v39, s[16:19], s44 offen offset:1024 lds
  v_mfma_f32_32x32x16_bf16 v[144:159], v[48:51], a[100:103], v[144:159]
  s_add_u32 s35, s40, 1
  s_and_b32 s35, s35, 3
  s_lshl_b32 s38, s32, 2
  s_add_u32 s35, s35, s38
  s_mul_i32 s35, s35, 7
  s_lshl_b32 s3, s35, 14
  s_lshl_b32 s41, s37, 7
  s_add_u32 s3, s3, s41
  s_add_u32 m0, s42, 18432
  s_add_u32 s44, s3, 32768
  buffer_load_dwordx4 v16, s[16:19], s44 offen lds
  buffer_load_dwordx4 v39, s[16:19], s44 offen offset:1024 lds
  s_waitcnt lgkmcnt(2)
  v_mfma_f32_32x32x16_bf16 v[160:175], v[52:55], a[96:99], v[160:175]
  s_add_u32 m0, s42, 20480
  s_add_u32 s44, s3, 49152
  buffer_load_dwordx4 v16, s[16:19], s44 offen lds
  buffer_load_dwordx4 v39, s[16:19], s44 offen offset:1024 lds
  v_mfma_f32_32x32x16_bf16 v[176:191], v[52:55], a[100:103], v[176:191]
  s_add_u32 m0, s42, 22528
  s_add_u32 s44, s3, 65536
  buffer_load_dwordx4 v16, s[16:19], s44 offen lds
  buffer_load_dwordx4 v39, s[16:19], s44 offen offset:1024 lds
  buffer_load_dword v32, v31, s[20:23], 0 offen offset:512 sc1
  s_waitcnt lgkmcnt(1)
  v_mfma_f32_32x32x16_bf16 v[128:143], v[56:59], a[104:107], v[128:143]
  ds_read_b128 v[48:51], v25 offset:0
  ds_read_b128 v[52:55], v25 offset:4096
  v_mfma_f32_32x32x16_bf16 v[144:159], v[56:59], a[108:111], v[144:159]
  s_waitcnt lgkmcnt(2)
  v_mfma_f32_32x32x16_bf16 v[160:175], v[60:63], a[104:107], v[160:175]
  v_mfma_f32_32x32x16_bf16 v[176:191], v[60:63], a[108:111], v[176:191]
  s_waitcnt lgkmcnt(1)
  v_mfma_f32_32x32x16_bf16 v[128:143], v[48:51], a[112:115], v[128:143]
  ds_read_b128 v[56:59], v26 offset:0
  ds_read_b128 v[60:63], v26 offset:4096
  v_mfma_f32_32x32x16_bf16 v[144:159], v[48:51], a[116:119], v[144:159]
  s_waitcnt lgkmcnt(2)
  v_mfma_f32_32x32x16_bf16 v[160:175], v[52:55], a[112:115], v[160:175]
  v_mfma_f32_32x32x16_bf16 v[176:191], v[52:55], a[116:119], v[176:191]
  s_waitcnt lgkmcnt(1)
  v_mfma_f32_32x32x16_bf16 v[128:143], v[56:59], a[120:123], v[128:143]
  s_waitcnt vmcnt(23)
  ds_read_b64_tr_b16 v[48:49], v21 offset:0
  ds_read_b64_tr_b16 v[50:51], v21 offset:512
  ds_read_b64_tr_b16 v[52:53], v22 offset:0
  ds_read_b64_tr_b16 v[54:55], v22 offset:512
  v_mfma_f32_32x32x16_bf16 v[144:159], v[56:59], a[124:127], v[144:159]
  s_waitcnt lgkmcnt(4)
  v_mfma_f32_32x32x16_bf16 v[160:175], v[60:63], a[120:123], v[160:175]
  v_mfma_f32_32x32x16_bf16 v[176:191], v[60:63], a[124:127], v[176:191]
  s_waitcnt lgkmcnt(2)
  v_mfma_f32_32x32x16_bf16 v[192:207], v[48:51], a[128:131], 0
  s_waitcnt vmcnt(21)
  ds_read_b64_tr_b16 v[56:57], v21 offset:2048
  ds_read_b64_tr_b16 v[58:59], v21 offset:2560
  ds_read_b64_tr_b16 v[60:61], v22 offset:2048
  ds_read_b64_tr_b16 v[62:63], v22 offset:2560
  s_add_u32 m0, s42, 0
  s_add_u32 s44, s3, 81920
  buffer_load_dwordx4 v16, s[16:19], s44 offen lds
  buffer_load_dwordx4 v39, s[16:19], s44 offen offset:1024 lds
  v_mfma_f32_32x32x16_bf16 v[208:223], v[48:51], a[132:135], 0
  s_add_u32 m0, s42, 2048
  s_add_u32 s44, s3, 98304
  buffer_load_dwordx4 v16, s[16:19], s44 offen lds
  buffer_load_dwordx4 v39, s[16:19], s44 offen offset:1024 lds
  s_waitcnt lgkmcnt(4)
  v_mfma_f32_32x32x16_bf16 v[224:239], v[52:55], a[128:131], 0
  s_add_u32 s35, s40, 2
  s_and_b32 s35, s35, 3
  s_lshl_b32 s38, s32, 2
  s_add_u32 s35, s35, s38
  s_mul_i32 s35, s35, 7
  s_lshl_b32 s3, s35, 14
  s_lshl_b32 s41, s37, 7
  s_add_u32 s3, s3, s41
  s_add_u32 m0, s42, 4096
  s_add_u32 s44, s3, 32768
  buffer_load_dwordx4 v16, s[16:19], s44 offen lds
  buffer_load_dwordx4 v39, s[16:19], s44 offen offset:1024 lds
  v_mfma_f32_32x32x16_bf16 v[240:255], v[52:55], a[132:135], 0
  s_add_u32 m0, s42, 6144
  s_add_u32 s44, s3, 49152
  buffer_load_dwordx4 v16, s[16:19], s44 offen lds
  buffer_load_dwordx4 v39, s[16:19], s44 offen offset:1024 lds
F_BBACK:
  s_waitcnt vmcnt(8)
  v_cmp_ne_u32 vcc, s50, v32
  s_nop 3
  s_cbranch_vccnz F_BSPIN
  s_waitcnt lgkmcnt(2)
  v_mfma_f32_32x32x16_bf16 v[192:207], v[56:59], a[136:139], v[192:207]
  ds_read_b64_tr_b16 v[48:49], v21 offset:4096
  ds_read_b64_tr_b16 v[50:51], v21 offset:4608
  ds_read_b64_tr_b16 v[52:53], v22 offset:4096
  ds_read_b64_tr_b16 v[54:55], v22 offset:4608
  s_add_u32 s35, s40, 0
  s_and_b32 s35, s35, 3
  s_lshl_b32 s38, s32, 2
  s_add_u32 s35, s35, s38
  s_mul_i32 s35, s35, 7
  s_lshl_b32 s101, s35, 10
  s_add_u32 s101, s101, s100
  s_add_u32 s51, s101, 2048
  buffer_load_dwordx4 a[0:3], v15, s[20:23], s51 offen sc1
  v_mfma_f32_32x32x16_bf16 v[208:223], v[56:59], a[140:143], v[208:223]
  s_add_u32 s51, s101, 116736
  buffer_load_dwordx4 a[4:7], v15, s[20:23], s51 offen sc1
  s_waitcnt lgkmcnt(4)
  v_mfma_f32_32x32x16_bf16 v[224:239], v[60:63], a[136:139], v[224:239]
  v_mfma_f32_32x32x16_bf16 v[240:255], v[60:63], a[140:143], v[240:255]
  s_waitcnt lgkmcnt(2)
  v_mfma_f32_32x32x16_bf16 v[192:207], v[48:51], a[144:147], v[192:207]
  ds_read_b64_tr_b16 v[56:57], v21 offset:6144
  ds_read_b64_tr_b16 v[58:59], v21 offset:6656
  ds_read_b64_tr_b16 v[60:61], v22 offset:6144
  ds_read_b64_tr_b16 v[62:63], v22 offset:6656
  s_add_u32 s51, s101, 3072
  buffer_load_dwordx4 a[8:11], v15, s[20:23], s51 offen sc1
  v_mfma_f32_32x32x16_bf16 v[208:223], v[48:51], a[148:151], v[208:223]
  s_add_u32 s51, s101, 117760
  buffer_load_dwordx4 a[12:15], v15, s[20:23], s51 offen sc1
  s_waitcnt lgkmcnt(4)
  v_mfma_f32_32x32x16_bf16 v[224:239], v[52:55], a[144:147], v[224:239]
  v_mfma_f32_32x32x16_bf16 v[240:255], v[52:55], a[148:151], v[240:255]
  s_waitcnt lgkmcnt(2)
  v_mfma_f32_32x32x16_bf16 v[192:207], v[56:59], a[152:155], v[192:207]
  ds_read_b64_tr_b16 v[48:49], v21 offset:8192
  ds_read_b64_tr_b16 v[50:51], v21 offset:8704
  ds_read_b64_tr_b16 v[52:53], v22 offset:8192
  ds_read_b64_tr_b16 v[54:55], v22 offset:8704
  s_add_u32 s51, s101, 4096
  buffer_load_dwordx4 a[16:19], v15, s[20:23], s51 offen sc1
  v_mfma_f32_32x32x16_bf16 v[208:223], v[56:59], a[156:159], v[208:223]
  s_add_u32 s51, s101, 118784
  buffer_load_dwordx4 a[20:23], v15, s[20:23], s51 offen sc1
  s_waitcnt lgkmcnt(4)
  v_mfma_f32_32x32x16_bf16 v[224:239], v[60:63], a[152:155], v[224:239]
  v_mfma_f32_32x32x16_bf16 v[240:255], v[60:63], a[156:159], v[240:255]
  s_waitcnt lgkmcnt(2)
  v_mfma_f32_32x32x16_bf16 v[192:207], v[48:51], a[160:163], v[192:207]
  ds_read_b64_tr_b16 v[56:57], v21 offset:10240
  ds_read_b64_tr_b16 v[58:59], v21 offset:10752
  ds_read_b64_tr_b16 v[60:61], v22 offset:10240
  ds_read_b64_tr_b16 v[62:63], v22 offset:10752
  s_add_u32 s51, s101, 5120
  buffer_load_dwordx4 a[24:27], v15, s[20:23], s51 offen sc1
  v_mfma_f32_32x32x16_bf16 v[208:223], v[48:51], a[164:167], v[208:223]
  s_add_u32 s51, s101, 119808
  buffer_load_dwordx4 a[28:31], v15, s[20:23], s51 offen sc1
  s_waitcnt lgkmcnt(4)
  v_mfma_f32_32x32x16_bf16 v[224:239], v[52:55], a[160:163], v[224:239]
  v_mfma_f32_32x32x16_bf16 v[240:255], v[52:55], a[164:167], v[240:255]
  s_waitcnt lgkmcnt(2)
  v_mfma_f32_32x32x16_bf16 v[192:207], v[56:59], a[168:171], v[192:207]
  ds_read_b64_tr_b16 v[48:49], v21 offset:12288
  ds_read_b64_tr_b16 v[50:51], v21 offset:12800
  ds_read_b64_tr_b16 v[52:53], v22 offset:12288
  ds_read_b64_tr_b16 v[54:55], v22 offset:12800
  s_add_u32 s51, s101, 6144
  buffer_load_dwordx4 a[32:35], v15, s[20:23], s51 offen sc1
  v_mfma_f32_32x32x16_bf16 v[208:223], v[56:59], a[172:175], v[208:223]
  s_add_u32 s51, s101, 120832
  buffer_load_dwordx4 a[36:39], v15, s[20:23], s51 offen sc1
  s_waitcnt lgkmcnt(4)
  v_mfma_f32_32x32x16_bf16 v[224:239], v[60:63], a[168:171], v[224:239]
  v_mfma_f32_32x32x16_bf16 v[240:255], v[60:63], a[172:175], v[240:255]
  s_waitcnt lgkmcnt(2)
  v_mfma_f32_32x32x16_bf16 v[192:207], v[48:51], a[176:179], v[192:207]
  ds_read_b64_tr_b16 v[56:57], v21 offset:14336
  ds_read_b64_tr_b16 v[58:59], v21 offset:14848
  ds_read_b64_tr_b16 v[60:61], v22 offset:14336
  ds_read_b64_tr_b16 v[62:63], v22 offset:14848
  s_add_u32 s35, s40, 1
  s_and_b32 s35, s35, 3
  s_lshl_b32 s38, s32, 2
  s_add_u32 s35, s35, s38
  s_mul_i32 s35, s35, 7
  s_lshl_b32 s101, s35, 10
  s_add_u32 s101, s101, s100
  s_add_u32 s51, s101, 2048
  buffer_load_dwordx4 a[40:43], v15, s[20:23], s51 offen sc1
  v_mfma_f32_32x32x16_bf16 v[208:223], v[48:51], a[180:183], v[208:223]
  s_add_u32 s51, s101, 116736
  buffer_load_dwordx4 a[44:47], v15, s[20:23], s51 offen sc1
  s_waitcnt lgkmcnt(4)
  v_mfma_f32_32x32x16_bf16 v[224:239], v[52:55], a[176:179], v[224:239]
  v_mfma_f32_32x32x16_bf16 v[240:255], v[52:55], a[180:183], v[240:255]
  s_waitcnt lgkmcnt(2)
  v_mfma_f32_32x32x16_bf16 v[192:207], v[56:59], a[184:187], v[192:207]
  s_waitcnt vmcnt(10)
  ds_read_b64_tr_b16 v[48:49], v19 offset:8192
  ds_read_b64_tr_b16 v[50:51], v19 offset:8704
  ds_read_b64_tr_b16 v[52:53], v20 offset:8192
  ds_read_b64_tr_b16 v[54:55], v20 offset:8704
  s_add_u32 s51, s101, 3072
  buffer_load_dwordx4 a[48:51], v15, s[20:23], s51 offen sc1
  v_mfma_f32_32x32x16_bf16 v[208:223], v[56:59], a[188:191], v[208:223]
  s_add_u32 s51, s101, 117760
  buffer_load_dwordx4 a[52:55], v15, s[20:23], s51 offen sc1
  s_waitcnt lgkmcnt(4)
  v_mfma_f32_32x32x16_bf16 v[224:239], v[60:63], a[184:187], v[224:239]
  v_mfma_f32_32x32x16_bf16 v[240:255], v[60:63], a[188:191], v[240:255]
  s_waitcnt lgkmcnt(2)
  v_mfma_f32_32x32x16_bf16 v[192:207], v[48:51], a[0:3], v[192:207]
  s_waitcnt vmcnt(10)
  ds_read_b64_tr_b16 v[56:57], v19 offset:10240
  ds_read_b64_tr_b16 v[58:59], v19 offset:10752
  ds_read_b64_tr_b16 v[60:61], v20 offset:10240
  ds_read_b64_tr_b16 v[62:63], v20 offset:10752
  s_add_u32 s51, s101, 4096
  buffer_load_dwordx4 a[56:59], v15, s[20:23], s51 offen sc1
  ds_write_b128 v40, v[128:131] offset:0
  ds_write_b128 v41, v[132:135] offset:0
  ds_write_b128 v42, v[136:139] offset:0
  v_mfma_f32_32x32x16_bf16 v[208:223], v[48:51], a[4:7], v[208:223]
  s_add_u32 s51, s101, 118784
  buffer_load_dwordx4 a[60:63], v15, s[20:23], s51 offen sc1
  ds_write_b128 v43, v[140:143] offset:0
  ds_write_b128 v40, v[144:147] offset:8192
  ds_write_b128 v41, v[148:151] offset:8192
  s_waitcnt lgkmcnt(10)
  v_mfma_f32_32x32x16_bf16 v[224:239], v[52:55], a[0:3], v[224:239]
  ds_write_b128 v42, v[152:155] offset:8192
  ds_write_b128 v43, v[156:159] offset:8192
  ds_write_b128 v40, v[160:163] offset:128
  v_mfma_f32_32x32x16_bf16 v[240:255], v[52:55], a[4:7], v[240:255]
  ds_write_b128 v41, v[164:167] offset:128
  ds_write_b128 v42, v[168:171] offset:128
  ds_write_b128 v43, v[172:175] offset:128
  s_waitcnt lgkmcnt(14)
  v_mfma_f32_32x32x16_bf16 v[192:207], v[56:59], a[8:11], v[192:207]
  s_waitcnt vmcnt(10)
  ds_read_b64_tr_b16 v[48:49], v19 offset:12288
  ds_read_b64_tr_b16 v[50:51], v19 offset:12800
  ds_read_b64_tr_b16 v[52:53], v20 offset:12288
  ds_read_b64_tr_b16 v[54:55], v20 offset:12800
  s_add_u32 m0, s42, 8192
  s_add_u32 s44, s3, 65536
  buffer_load_dwordx4 v16, s[16:19], s44 offen lds
  ds_write_b128 v40, v[176:179] offset:8320
  ds_write_b128 v41, v[180:183] offset:8320
  ds_write_b128 v42, v[184:187] offset:8320
  v_mfma_f32_32x32x16_bf16 v[208:223], v[56:59], a[12:15], v[208:223]
  buffer_load_dwordx4 v39, s[16:19], s44 offen offset:1024 lds
  ds_write_b128 v43, v[188:191] offset:8320
  v_lshlrev_b32 v82, 16, v80
  v_and_b32 v83, 0xffff0000, v80
  s_waitcnt lgkmcnt(15)
  v_mfma_f32_32x32x16_bf16 v[224:239], v[60:63], a[8:11], v[224:239]
  s_add_u32 s51, s101, 5120
  buffer_load_dwordx4 a[64:67], v15, s[20:23], s51 offen sc1
  v_lshlrev_b32_e64 v84, 16, v81
  v_and_b32 v85, 0xffff0000, v81
  v_lshlrev_b32_e64 v88, 16, v64
  v_mfma_f32_32x32x16_bf16 v[240:255], v[60:63], a[12:15], v[240:255]
  s_add_u32 s51, s101, 119808
  buffer_load_dwordx4 a[68:71], v15, s[20:23], s51 offen sc1
  v_and_b32 v89, 0xffff0000, v64
  v_lshlrev_b32_e64 v90, 16, v65
  v_and_b32 v91, 0xffff0000, v65
  s_waitcnt lgkmcnt(6)
  v_mfma_f32_32x32x16_bf16 v[192:207], v[48:51], a[16:19], v[192:207]
  s_waitcnt vmcnt(12)
  ds_read_b64_tr_b16 v[56:57], v19 offset:14336
  ds_read_b64_tr_b16 v[58:59], v19 offset:14848
  ds_read_b64_tr_b16 v[60:61], v20 offset:14336
  ds_read_b64_tr_b16 v[62:63], v20 offset:14848
  s_add_u32 m0, s42, 10240
  s_add_u32 s44, s3, 81920
  buffer_load_dwordx4 v16, s[16:19], s44 offen lds
  v_sub_f32 v104, v88, v72
  v_sub_f32 v105, v89, v72
  v_sub_f32_e64 v106, v90, v72
  v_mfma_f32_32x32x16_bf16 v[208:223], v[48:51], a[20:23], v[208:223]
  buffer_load_dwordx4 v39, s[16:19], s44 offen offset:1024 lds
  v_sub_f32 v107, v91, v72
  v_mul_f32 v104, v104, v73
  v_mul_f32 v105, v105, v73
  s_waitcnt lgkmcnt(8)
  v_mfma_f32_32x32x16_bf16 v[224:239], v[52:55], a[16:19], v[224:239]
  s_add_u32 s51, s101, 6144
  buffer_load_dwordx4 a[72:75], v15, s[20:23], s51 offen sc1
  v_mul_f32 v106, v106, v73
  v_mul_f32 v107, v107, v73
  v_mul_f32_e64 v104, v104, v82
  v_mfma_f32_32x32x16_bf16 v[240:255], v[52:55], a[20:23], v[240:255]
  s_add_u32 s51, s101, 120832
  buffer_load_dwordx4 a[76:79], v15, s[20:23], s51 offen sc1
  v_mul_f32 v105, v105, v83
  v_mul_f32 v106, v106, v84
  v_mul_f32_e64 v107, v107, v85
  s_waitcnt lgkmcnt(2)
  v_mfma_f32_32x32x16_bf16 v[192:207], v[56:59], a[24:27], v[192:207]
  s_waitcnt vmcnt(14)
  ds_read_b64_tr_b16 v[48:49], v19 offset:16384
  ds_read_b64_tr_b16 v[50:51], v19 offset:16896
  ds_read_b64_tr_b16 v[52:53], v20 offset:16384
  ds_read_b64_tr_b16 v[54:55], v20 offset:16896
  s_add_u32 m0, s42, 12288
  s_add_u32 s44, s3, 98304
  buffer_load_dwordx4 v16, s[16:19], s44 offen lds
  v_lshlrev_b32_e64 v92, 16, v66
  v_and_b32 v93, 0xffff0000, v66
  v_lshlrev_b32_e64 v94, 16, v67
  v_mfma_f32_32x32x16_bf16 v[208:223], v[56:59], a[28:31], v[208:223]
  buffer_load_dwordx4 v39, s[16:19], s44 offen offset:1024 lds
  v_and_b32 v95, 0xffff0000, v67
  v_sub_f32 v108, v92, v74
  v_sub_f32 v109, v93, v74
  s_waitcnt lgkmcnt(4)
  v_mfma_f32_32x32x16_bf16 v[224:239], v[60:63], a[24:27], v[224:239]
  s_add_u32 s35, s40, 2
  s_and_b32 s35, s35, 3
  s_lshl_b32 s38, s32, 2
  s_add_u32 s35, s35, s38
  s_mul_i32 s35, s35, 7
  s_lshl_b32 s101, s35, 10
  s_add_u32 s101, s101, s100
  s_add_u32 s51, s101, 2048
  buffer_load_dwordx4 a[80:83], v15, s[20:23], s51 offen sc1
  v_sub_f32 v110, v94, v74
  v_sub_f32 v111, v95, v74
  v_mul_f32_e64 v108, v108, v75
  v_mfma_f32_32x32x16_bf16 v[240:255], v[60:63], a[28:31], v[240:255]
  s_add_u32 s51, s101, 116736
  buffer_load_dwordx4 a[84:87], v15, s[20:23], s51 offen sc1
  v_mul_f32 v109, v109, v75
  v_mul_f32 v110, v110, v75
  v_mul_f32_e64 v111, v111, v75
  s_waitcnt lgkmcnt(2)
  v_mfma_f32_32x32x16_bf16 v[192:207], v[48:51], a[32:35], v[192:207]
  s_waitcnt vmcnt(16)
  ds_read_b64_tr_b16 v[56:57], v19 offset:18432
  ds_read_b64_tr_b16 v[58:59], v19 offset:18944
  ds_read_b64_tr_b16 v[60:61], v20 offset:18432
  ds_read_b64_tr_b16 v[62:63], v20 offset:18944
  s_add_u32 s35, s40, 3
  s_and_b32 s35, s35, 3
  s_lshl_b32 s38, s32, 2
  s_add_u32 s35, s35, s38
  s_mul_i32 s35, s35, 7
  s_lshl_b32 s3, s35, 14
  s_lshl_b32 s41, s37, 7
  s_add_u32 s3, s3, s41
  s_add_u32 m0, s42, 14336
  s_add_u32 s44, s3, 32768
  buffer_load_dwordx4 v16, s[16:19], s44 offen lds
  v_mul_f32 v108, v108, v82
  v_mul_f32 v109, v109, v83
  v_mul_f32_e64 v110, v110, v84
  v_mfma_f32_32x32x16_bf16 v[208:223], v[48:51], a[36:39], v[208:223]
  buffer_load_dwordx4 v39, s[16:19], s44 offen offset:1024 lds
  v_mul_f32_e64 v111, v111, v85
  v_lshlrev_b32 v96, 16, v68
  v_and_b32 v97, 0xffff0000, v68
  s_waitcnt lgkmcnt(4)
  v_mfma_f32_32x32x16_bf16 v[224:239], v[52:55], a[32:35], v[224:239]
  s_add_u32 s51, s101, 3072
  buffer_load_dwordx4 a[88:91], v15, s[20:23], s51 offen sc1
  v_lshlrev_b32_e64 v98, 16, v69
  v_and_b32 v99, 0xffff0000, v69
  v_sub_f32_e64 v112, v96, v76
  v_mfma_f32_32x32x16_bf16 v[240:255], v[52:55], a[36:39], v[240:255]
  s_add_u32 s51, s101, 117760
  buffer_load_dwordx4 a[92:95], v15, s[20:23], s51 offen sc1
  v_sub_f32 v113, v97, v76
  v_sub_f32 v114, v98, v76
  v_sub_f32_e64 v115, v99, v76
  s_waitcnt lgkmcnt(2)
  v_mfma_f32_32x32x16_bf16 v[192:207], v[56:59], a[40:43], v[192:207]
  s_waitcnt vmcnt(18)
  ds_read_b64_tr_b16 v[48:49], v19 offset:20480
  ds_read_b64_tr_b16 v[50:51], v19 offset:20992
  ds_read_b64_tr_b16 v[52:53], v20 offset:20480
  ds_read_b64_tr_b16 v[54:55], v20 offset:20992
  s_add_u32 m0, s42, 16384
  s_add_u32 s44, s3, 49152
  buffer_load_dwordx4 v16, s[16:19], s44 offen lds
  v_mul_f32 v112, v112, v77
  v_mul_f32 v113, v113, v77
  v_mul_f32_e64 v114, v114, v77
  v_mfma_f32_32x32x16_bf16 v[208:223], v[56:59], a[44:47], v[208:223]
  buffer_load_dwordx4 v39, s[16:19], s44 offen offset:1024 lds
  v_mul_f32 v115, v115, v77
  v_mul_f32 v112, v112, v82
  v_mul_f32 v113, v113, v83
  s_waitcnt lgkmcnt(4)
  v_mfma_f32_32x32x16_bf16 v[224:239], v[60:63], a[40:43], v[224:239]
  s_add_u32 s51, s101, 4096
  buffer_load_dwordx4 a[96:99], v15, s[20:23], s51 offen sc1
  v_mul_f32 v114, v114, v84
  v_mul_f32 v115, v115, v85
  v_lshlrev_b32_e64 v100, 16, v70
  v_mfma_f32_32x32x16_bf16 v[240:255], v[60:63], a[44:47], v[240:255]
  s_add_u32 s51, s101, 118784
  buffer_load_dwordx4 a[100:103], v15, s[20:23], s51 offen sc1
  v_and_b32 v101, 0xffff0000, v70
  v_lshlrev_b32 v102, 16, v71
  v_and_b32 v103, 0xffff0000, v71
  s_waitcnt lgkmcnt(0)
  s_barrier
  v_mfma_f32_32x32x16_bf16 v[192:207], v[48:51], a[48:51], v[192:207]
  s_waitcnt vmcnt(20)
  ds_read_b64_tr_b16 v[56:57], v19 offset:22528
  ds_read_b64_tr_b16 v[58:59], v19 offset:23040
  ds_read_b64_tr_b16 v[60:61], v20 offset:22528
  ds_read_b64_tr_b16 v[62:63], v20 offset:23040
  s_add_u32 m0, s42, 18432
  s_add_u32 s44, s3, 65536
  buffer_load_dwordx4 v16, s[16:19], s44 offen lds
  v_sub_f32 v116, v100, v78
  v_sub_f32 v117, v101, v78
  v_sub_f32_e64 v118, v102, v78
  v_mfma_f32_32x32x16_bf16 v[208:223], v[48:51], a[52:55], v[208:223]
  buffer_load_dwordx4 v39, s[16:19], s44 offen offset:1024 lds
  v_sub_f32 v119, v103, v78
  v_mul_f32 v116, v116, v79
  v_mul_f32_e64 v117, v117, v79
  v_mfma_f32_32x32x16_bf16 v[224:239], v[52:55], a[48:51], v[224:239]
  s_add_u32 s51, s101, 5120
  buffer_load_dwordx4 a[104:107], v15, s[20:23], s51 offen sc1
  v_mul_f32 v118, v118, v79
  v_mul_f32 v119, v119, v79
  v_mul_f32_e64 v116, v116, v82
  v_mfma_f32_32x32x16_bf16 v[240:255], v[52:55], a[52:55], v[240:255]
  s_add_u32 s51, s101, 119808
  buffer_load_dwordx4 a[108:111], v15, s[20:23], s51 offen sc1
  v_mul_f32 v117, v117, v83
  v_mul_f32 v118, v118, v84
  v_mul_f32_e64 v119, v119, v85
  s_waitcnt lgkmcnt(2)
  v_mfma_f32_32x32x16_bf16 v[192:207], v[56:59], a[56:59], v[192:207]
  s_waitcnt vmcnt(20)
  ds_read_b64_tr_b16 v[48:49], v19 offset:0
  ds_read_b64_tr_b16 v[50:51], v19 offset:512
  ds_read_b64_tr_b16 v[52:53], v20 offset:0
  ds_read_b64_tr_b16 v[54:55], v20 offset:512
  s_add_u32 m0, s42, 20480
  s_add_u32 s44, s3, 81920
  buffer_load_dwordx4 v16, s[16:19], s44 offen lds
  ds_read_b128 v[128:131], v44 offset:0
  ds_read_b128 v[132:135], v44 offset:16384
  ds_read_b128 v[136:139], v44 offset:32768
  v_mfma_f32_32x32x16_bf16 v[208:223], v[56:59], a[60:63], v[208:223]
  buffer_load_dwordx4 v39, s[16:19], s44 offen offset:1024 lds
  ds_read_b128 v[140:143], v44 offset:49152
  ds_read_b128 v[144:147], v44 offset:1024
  ds_read_b128 v[148:151], v44 offset:17408
  s_waitcnt lgkmcnt(10)
  v_mfma_f32_32x32x16_bf16 v[224:239], v[60:63], a[56:59], v[224:239]
  s_add_u32 s51, s101, 6144
  buffer_load_dwordx4 a[112:115], v15, s[20:23], s51 offen sc1
  ds_read_b128 v[152:155], v44 offset:33792
  ds_read_b128 v[156:159], v44 offset:50176
  s_waitcnt lgkmcnt(7)
  v_add_f32_e64 v104, v104, v128
  v_mfma_f32_32x32x16_bf16 v[240:255], v[60:63], a[60:63], v[240:255]
  s_add_u32 s51, s101, 120832
  buffer_load_dwordx4 a[116:119], v15, s[20:23], s51 offen sc1
  v_add_f32 v105, v105, v129
  v_add_f32 v106, v106, v130
  v_add_f32 v107, v107, v131
  v_mfma_f32_32x32x16_bf16 v[192:207], v[48:51], a[64:67], v[192:207]
  s_waitcnt vmcnt(20)
  ds_read_b64_tr_b16 v[56:57], v19 offset:2048
  ds_read_b64_tr_b16 v[58:59], v19 offset:2560
  ds_read_b64_tr_b16 v[60:61], v20 offset:2048
  ds_read_b64_tr_b16 v[62:63], v20 offset:2560
  s_add_u32 m0, s42, 22528
  s_add_u32 s44, s3, 98304
  buffer_load_dwordx4 v16, s[16:19], s44 offen lds
  s_waitcnt lgkmcnt(10)
  v_add_f32 v104, v104, v132
  v_add_f32 v105, v105, v133
  v_add_f32 v106, v106, v134
  v_mfma_f32_32x32x16_bf16 v[208:223], v[48:51], a[68:71], v[208:223]
  buffer_load_dwordx4 v39, s[16:19], s44 offen offset:1024 lds
  v_add_f32 v107, v107, v135
  s_waitcnt lgkmcnt(9)
  v_add_f32_e64 v104, v104, v136
  v_add_f32 v105, v105, v137
  v_mfma_f32_32x32x16_bf16 v[224:239], v[52:55], a[64:67], v[224:239]
  s_add_u32 s35, s40, 3
  s_and_b32 s35, s35, 3
  s_lshl_b32 s38, s32, 2
  s_add_u32 s35, s35, s38
  s_mul_i32 s35, s35, 7
  s_lshl_b32 s101, s35, 10
  s_add_u32 s101, s101, s100
  s_add_u32 s51, s101, 2048
  buffer_load_dwordx4 a[120:123], v15, s[20:23], s51 offen sc1
  v_add_f32 v106, v106, v138
  v_add_f32 v107, v107, v139
  s_waitcnt lgkmcnt(8)
  v_add_f32 v104, v104, v140
  v_mfma_f32_32x32x16_bf16 v[240:255], v[52:55], a[68:71], v[240:255]
  s_add_u32 s51, s101, 116736
  buffer_load_dwordx4 a[124:127], v15, s[20:23], s51 offen sc1
  v_add_f32 v105, v105, v141
  v_add_f32 v106, v106, v142
  v_add_f32_e64 v107, v107, v143
  s_waitcnt lgkmcnt(2)
  v_mfma_f32_32x32x16_bf16 v[192:207], v[56:59], a[72:75], v[192:207]
  s_waitcnt vmcnt(20)
  ds_read_b64_tr_b16 v[48:49], v19 offset:4096
  ds_read_b64_tr_b16 v[50:51], v19 offset:4608
  ds_read_b64_tr_b16 v[52:53], v20 offset:4096
  ds_read_b64_tr_b16 v[54:55], v20 offset:4608
  s_add_u32 s51, s101, 3072
  buffer_load_dwordx4 a[128:131], v15, s[20:23], s51 offen sc1
  ds_read_b128 v[160:163], v44 offset:2048
  ds_read_b128 v[164:167], v44 offset:18432
  ds_read_b128 v[168:171], v44 offset:34816
  v_mfma_f32_32x32x16_bf16 v[208:223], v[56:59], a[76:79], v[208:223]
  s_add_u32 s51, s101, 117760
  buffer_load_dwordx4 a[132:135], v15, s[20:23], s51 offen sc1
  ds_read_b128 v[172:175], v44 offset:51200
  v_add_f32_e64 v108, v108, v144
  v_add_f32 v109, v109, v145
  s_waitcnt lgkmcnt(8)
  v_mfma_f32_32x32x16_bf16 v[224:239], v[60:63], a[72:75], v[224:239]
  v_add_f32 v110, v110, v146
  v_add_f32 v111, v111, v147
  v_add_f32_e64 v108, v108, v148
  v_mfma_f32_32x32x16_bf16 v[240:255], v[60:63], a[76:79], v[240:255]
  v_add_f32 v109, v109, v149
  v_add_f32 v110, v110, v150
  v_add_f32_e64 v111, v111, v151
  s_waitcnt lgkmcnt(6)
  v_mfma_f32_32x32x16_bf16 v[192:207], v[48:51], a[80:83], v[192:207]
  s_waitcnt vmcnt(18)
  ds_read_b64_tr_b16 v[56:57], v19 offset:6144
  ds_read_b64_tr_b16 v[58:59], v19 offset:6656
  ds_read_b64_tr_b16 v[60:61], v20 offset:6144
  ds_read_b64_tr_b16 v[62:63], v20 offset:6656
  s_add_u32 s51, s101, 4096
  buffer_load_dwordx4 a[136:139], v15, s[20:23], s51 offen sc1
  v_add_f32 v108, v108, v152
  v_add_f32 v109, v109, v153
  v_add_f32_e64 v110, v110, v154
  v_mfma_f32_32x32x16_bf16 v[208:223], v[48:51], a[84:87], v[208:223]
  s_add_u32 s51, s101, 118784
  buffer_load_dwordx4 a[140:143], v15, s[20:23], s51 offen sc1
  v_add_f32 v111, v111, v155
  v_add_f32 v108, v108, v156
  v_add_f32 v109, v109, v157
  s_waitcnt lgkmcnt(8)
  v_mfma_f32_32x32x16_bf16 v[224:239], v[52:55], a[80:83], v[224:239]
  v_add_f32 v110, v110, v158
  v_add_f32 v111, v111, v159
  ds_read_b128 v[176:179], v44 offset:3072
  v_mfma_f32_32x32x16_bf16 v[240:255], v[52:55], a[84:87], v[240:255]
  ds_read_b128 v[180:183], v44 offset:19456
  ds_read_b128 v[184:187], v44 offset:35840
  ds_read_b128 v[188:191], v44 offset:52224
  s_waitcnt lgkmcnt(6)
  v_mfma_f32_32x32x16_bf16 v[192:207], v[56:59], a[88:91], v[192:207]
  s_waitcnt vmcnt(16)
  ds_read_b64_tr_b16 v[48:49], v19 offset:8192
  ds_read_b64_tr_b16 v[50:51], v19 offset:8704
  ds_read_b64_tr_b16 v[52:53], v20 offset:8192
  ds_read_b64_tr_b16 v[54:55], v20 offset:8704
  s_add_u32 s51, s101, 5120
  buffer_load_dwordx4 a[144:147], v15, s[20:23], s51 offen sc1
  v_add_f32 v112, v112, v160
  v_add_f32 v113, v113, v161
  v_add_f32_e64 v114, v114, v162
  v_mfma_f32_32x32x16_bf16 v[208:223], v[56:59], a[92:95], v[208:223]
  s_add_u32 s51, s101, 119808
  buffer_load_dwordx4 a[148:151], v15, s[20:23], s51 offen sc1
  v_add_f32 v115, v115, v163
  v_add_f32 v112, v112, v164
  v_add_f32 v113, v113, v165
  s_waitcnt lgkmcnt(8)
  v_mfma_f32_32x32x16_bf16 v[224:239], v[60:63], a[88:91], v[224:239]
  v_add_f32 v114, v114, v166
  v_add_f32 v115, v115, v167
  v_add_f32_e64 v112, v112, v168
  v_mfma_f32_32x32x16_bf16 v[240:255], v[60:63], a[92:95], v[240:255]
  v_add_f32 v113, v113, v169
  v_add_f32 v114, v114, v170
  v_add_f32_e64 v115, v115, v171
  s_waitcnt lgkmcnt(2)
  v_mfma_f32_32x32x16_bf16 v[192:207], v[48:51], a[96:99], v[192:207]
  s_waitcnt vmcnt(14)
  ds_read_b64_tr_b16 v[56:57], v19 offset:10240
  ds_read_b64_tr_b16 v[58:59], v19 offset:10752
  ds_read_b64_tr_b16 v[60:61], v20 offset:10240
  ds_read_b64_tr_b16 v[62:63], v20 offset:10752
  s_add_u32 s51, s101, 6144
  buffer_load_dwordx4 a[152:155], v15, s[20:23], s51 offen sc1
  v_add_f32 v112, v112, v172
  v_add_f32 v113, v113, v173
  v_add_f32_e64 v114, v114, v174
  v_mfma_f32_32x32x16_bf16 v[208:223], v[48:51], a[100:103], v[208:223]
  s_add_u32 s51, s101, 120832
  buffer_load_dwordx4 a[156:159], v15, s[20:23], s51 offen sc1
  v_add_f32 v115, v115, v175
  v_add_f32 v116, v116, v176
  v_add_f32 v117, v117, v177
  s_waitcnt lgkmcnt(4)
  v_mfma_f32_32x32x16_bf16 v[224:239], v[52:55], a[96:99], v[224:239]
  v_add_f32 v118, v118, v178
  v_add_f32 v119, v119, v179
  v_add_f32_e64 v116, v116, v180
  v_mfma_f32_32x32x16_bf16 v[240:255], v[52:55], a[100:103], v[240:255]
  v_add_f32 v117, v117, v181
  v_add_f32 v118, v118, v182
  v_add_f32_e64 v119, v119, v183
  s_waitcnt lgkmcnt(2)
  v_mfma_f32_32x32x16_bf16 v[192:207], v[56:59], a[104:107], v[192:207]
  s_waitcnt vmcnt(12)
  ds_read_b64_tr_b16 v[48:49], v19 offset:12288
  ds_read_b64_tr_b16 v[50:51], v19 offset:12800
  ds_read_b64_tr_b16 v[52:53], v20 offset:12288
  ds_read_b64_tr_b16 v[54:55], v20 offset:12800
  v_add_f32 v116, v116, v184
  v_add_f32 v117, v117, v185
  v_add_f32_e64 v118, v118, v186
  v_mfma_f32_32x32x16_bf16 v[208:223], v[56:59], a[108:111], v[208:223]
  v_add_f32 v119, v119, v187
  v_add_f32 v116, v116, v188
  v_add_f32 v117, v117, v189
  s_waitcnt lgkmcnt(4)
  v_mfma_f32_32x32x16_bf16 v[224:239], v[60:63], a[104:107], v[224:239]
  v_add_f32 v118, v118, v190
  v_add_f32 v119, v119, v191
  v_mfma_f32_32x32x16_bf16 v[240:255], v[60:63], a[108:111], v[240:255]
  s_waitcnt lgkmcnt(2)
  v_mfma_f32_32x32x16_bf16 v[192:207], v[48:51], a[112:115], v[192:207]
  s_waitcnt vmcnt(8)
  ds_read_b64_tr_b16 v[56:57], v19 offset:14336
  ds_read_b64_tr_b16 v[58:59], v19 offset:14848
  ds_read_b64_tr_b16 v[60:61], v20 offset:14336
  ds_read_b64_tr_b16 v[62:63], v20 offset:14848
  v_mfma_f32_32x32x16_bf16 v[208:223], v[48:51], a[116:119], v[208:223]
  s_waitcnt lgkmcnt(4)
  v_mfma_f32_32x32x16_bf16 v[224:239], v[52:55], a[112:115], v[224:239]
  v_mfma_f32_32x32x16_bf16 v[240:255], v[52:55], a[116:119], v[240:255]
  s_waitcnt lgkmcnt(2)
  v_mfma_f32_32x32x16_bf16 v[192:207], v[56:59], a[120:123], v[192:207]
  s_waitcnt vmcnt(6)
  ds_read_b64_tr_b16 v[48:49], v19 offset:16384
  ds_read_b64_tr_b16 v[50:51], v19 offset:16896
  ds_read_b64_tr_b16 v[52:53], v20 offset:16384
  ds_read_b64_tr_b16 v[54:55], v20 offset:16896
  v_mfma_f32_32x32x16_bf16 v[208:223], v[56:59], a[124:127], v[208:223]
  s_waitcnt lgkmcnt(4)
  v_mfma_f32_32x32x16_bf16 v[224:239], v[60:63], a[120:123], v[224:239]
  v_mfma_f32_32x32x16_bf16 v[240:255], v[60:63], a[124:127], v[240:255]
  s_waitcnt lgkmcnt(2)
  v_mfma_f32_32x32x16_bf16 v[192:207], v[48:51], a[128:131], v[192:207]
  s_waitcnt vmcnt(4)
  ds_read_b64_tr_b16 v[56:57], v19 offset:18432
  ds_read_b64_tr_b16 v[58:59], v19 offset:18944
  ds_read_b64_tr_b16 v[60:61], v20 offset:18432
  ds_read_b64_tr_b16 v[62:63], v20 offset:18944
  v_mfma_f32_32x32x16_bf16 v[208:223], v[48:51], a[132:135], v[208:223]
  s_waitcnt lgkmcnt(4)
  v_mfma_f32_32x32x16_bf16 v[224:239], v[52:55], a[128:131], v[224:239]
  v_mfma_f32_32x32x16_bf16 v[240:255], v[52:55], a[132:135], v[240:255]
  s_waitcnt lgkmcnt(2)
  v_mfma_f32_32x32x16_bf16 v[192:207], v[56:59], a[136:139], v[192:207]
  s_waitcnt vmcnt(2)
  ds_read_b64_tr_b16 v[48:49], v19 offset:20480
  ds_read_b64_tr_b16 v[50:51], v19 offset:20992
  ds_read_b64_tr_b16 v[52:53], v20 offset:20480
  ds_read_b64_tr_b16 v[54:55], v20 offset:20992
  v_mfma_f32_32x32x16_bf16 v[208:223], v[56:59], a[140:143], v[208:223]
  s_waitcnt lgkmcnt(4)
  v_mfma_f32_32x32x16_bf16 v[224:239], v[60:63], a[136:139], v[224:239]
  v_mfma_f32_32x32x16_bf16 v[240:255], v[60:63], a[140:143], v[240:255]
  s_waitcnt lgkmcnt(2)
  v_mfma_f32_32x32x16_bf16 v[192:207], v[48:51], a[144:147], v[192:207]
  s_waitcnt vmcnt(0)
  ds_read_b64_tr_b16 v[56:57], v19 offset:22528
  ds_read_b64_tr_b16 v[58:59], v19 offset:23040
  ds_read_b64_tr_b16 v[60:61], v20 offset:22528
  ds_read_b64_tr_b16 v[62:63], v20 offset:23040
  v_mfma_f32_32x32x16_bf16 v[208:223], v[48:51], a[148:151], v[208:223]
  s_waitcnt lgkmcnt(4)
  v_mfma_f32_32x32x16_bf16 v[224:239], v[52:55], a[144:147], v[224:239]
  v_mfma_f32_32x32x16_bf16 v[240:255], v[52:55], a[148:151], v[240:255]
  s_waitcnt lgkmcnt(2)
  v_mfma_f32_32x32x16_bf16 v[192:207], v[56:59], a[152:155], v[192:207]
  v_mfma_f32_32x32x16_bf16 v[208:223], v[56:59], a[156:159], v[208:223]
  s_waitcnt lgkmcnt(0)
  v_mfma_f32_32x32x16_bf16 v[224:239], v[60:63], a[152:155], v[224:239]
  v_mfma_f32_32x32x16_bf16 v[240:255], v[60:63], a[156:159], v[240:255]
  s_nop 7
  ds_write_b128 v120, v[192:195] offset:0
  ds_write_b128 v121, v[196:199] offset:0
  ds_write_b128 v122, v[200:203] offset:0
  ds_write_b128 v123, v[204:207] offset:0
  ds_write_b128 v120, v[208:211] offset:8192
  ds_write_b128 v121, v[212:215] offset:8192
  ds_write_b128 v122, v[216:219] offset:8192
  ds_write_b128 v123, v[220:223] offset:8192
  ds_write_b128 v120, v[224:227] offset:128
  ds_write_b128 v121, v[228:231] offset:128
  ds_write_b128 v122, v[232:235] offset:128
  ds_write_b128 v123, v[236:239] offset:128
  ds_write_b128 v120, v[240:243] offset:8320
  ds_write_b128 v121, v[244:247] offset:8320
  ds_write_b128 v122, v[248:251] offset:8320
  ds_write_b128 v123, v[252:255] offset:8320
  s_waitcnt lgkmcnt(0)
  s_barrier
  ds_read_b128 v[128:131], v45 offset:0
  ds_read_b128 v[132:135], v45 offset:24576
  ds_read_b128 v[136:139], v45 offset:49152
  ds_read_b128 v[140:143], v46 offset:0
  ds_read_b128 v[144:147], v45 offset:1024
  ds_read_b128 v[148:151], v45 offset:25600
  ds_read_b128 v[152:155], v45 offset:50176
  ds_read_b128 v[156:159], v46 offset:1024
  ds_read_b128 v[160:163], v45 offset:2048
  ds_read_b128 v[164:167], v45 offset:26624
  ds_read_b128 v[168:171], v45 offset:51200
  ds_read_b128 v[172:175], v46 offset:2048
  ds_read_b128 v[176:179], v45 offset:3072
  ds_read_b128 v[180:183], v45 offset:27648
  ds_read_b128 v[184:187], v45 offset:52224
  ds_read_b128 v[188:191], v46 offset:3072
  s_waitcnt lgkmcnt(14)
  v_pk_add_f32 v[128:129], v[128:129], v[132:133]
  s_waitcnt lgkmcnt(12)
  v_pk_add_f32 v[136:137], v[136:137], v[140:141]
  v_pk_add_f32 v[130:131], v[130:131], v[134:135]
  v_pk_add_f32 v[138:139], v[138:139], v[142:143]
  v_pk_add_f32 v[128:129], v[128:129], v[136:137]
  v_pk_add_f32 v[130:131], v[130:131], v[138:139]
  s_waitcnt lgkmcnt(10)
  v_pk_add_f32 v[144:145], v[144:145], v[148:149]
  s_waitcnt lgkmcnt(8)
  v_pk_add_f32 v[152:153], v[152:153], v[156:157]
  v_pk_add_f32 v[146:147], v[146:147], v[150:151]
  v_pk_add_f32 v[154:155], v[154:155], v[158:159]
  v_pk_add_f32 v[144:145], v[144:145], v[152:153]
  v_pk_add_f32 v[146:147], v[146:147], v[154:155]
  s_waitcnt lgkmcnt(6)
  v_pk_add_f32 v[160:161], v[160:161], v[164:165]
  s_waitcnt lgkmcnt(4)
  v_pk_add_f32 v[168:169], v[168:169], v[172:173]
  v_pk_add_f32 v[162:163], v[162:163], v[166:167]
  v_pk_add_f32 v[170:171], v[170:171], v[174:175]
  v_pk_add_f32 v[160:161], v[160:161], v[168:169]
  v_pk_add_f32 v[162:163], v[162:163], v[170:171]
  s_waitcnt lgkmcnt(2)
  v_pk_add_f32 v[176:177], v[176:177], v[180:181]
  s_waitcnt lgkmcnt(0)
  v_pk_add_f32 v[184:185], v[184:185], v[188:189]
  v_pk_add_f32 v[178:179], v[178:179], v[182:183]
  v_pk_add_f32 v[186:187], v[186:187], v[190:191]
  v_pk_add_f32 v[176:177], v[176:177], v[184:185]
  v_pk_add_f32 v[178:179], v[178:179], v[186:187]
  s_mov_b32 s35, 0xbfb8aa3b
  v_mul_f32 v132, s35, v128
  v_mul_f32 v133, s35, v129
  v_mul_f32 v134, s35, v130
  v_mul_f32 v135, s35, v131
  v_mul_f32 v148, s35, v144
  v_mul_f32 v149, s35, v145
  v_mul_f32 v150, s35, v146
  v_mul_f32 v151, s35, v147
  v_mul_f32 v164, s35, v160
  v_mul_f32 v165, s35, v161
  v_mul_f32 v166, s35, v162
  v_mul_f32 v167, s35, v163
  v_mul_f32 v180, s35, v176
  v_mul_f32 v181, s35, v177
  v_mul_f32 v182, s35, v178
  v_mul_f32 v183, s35, v179
  v_exp_f32 v132, v132
  v_exp_f32 v133, v133
  v_exp_f32 v134, v134
  v_exp_f32 v135, v135
  v_exp_f32 v148, v148
  v_exp_f32 v149, v149
  v_exp_f32 v150, v150
  v_exp_f32 v151, v151
  v_exp_f32 v164, v164
  v_exp_f32 v165, v165
  v_exp_f32 v166, v166
  v_exp_f32 v167, v167
  v_exp_f32 v180, v180
  v_exp_f32 v181, v181
  v_exp_f32 v182, v182
  v_exp_f32 v183, v183
  v_pk_mul_f32 v[128:129], v[128:129], v[104:105]
  v_pk_mul_f32 v[130:131], v[130:131], v[106:107]
  v_add_f32 v132, 1.0, v132
  v_add_f32 v133, 1.0, v133
  v_add_f32 v134, 1.0, v134
  v_add_f32 v135, 1.0, v135
  v_pk_mul_f32 v[144:145], v[144:145], v[108:109]
  v_pk_mul_f32 v[146:147], v[146:147], v[110:111]
  v_add_f32 v148, 1.0, v148
  v_add_f32 v149, 1.0, v149
  v_add_f32 v150, 1.0, v150
  v_add_f32 v151, 1.0, v151
  v_pk_mul_f32 v[160:161], v[160:161], v[112:113]
  v_pk_mul_f32 v[162:163], v[162:163], v[114:115]
  v_add_f32 v164, 1.0, v164
  v_add_f32 v165, 1.0, v165
  v_add_f32 v166, 1.0, v166
  v_add_f32 v167, 1.0, v167
  v_pk_mul_f32 v[176:177], v[176:177], v[116:117]
  v_pk_mul_f32 v[178:179], v[178:179], v[118:119]
  v_add_f32 v180, 1.0, v180
  v_add_f32 v181, 1.0, v181
  v_add_f32 v182, 1.0, v182
  v_add_f32 v183, 1.0, v183
  v_rcp_f32 v132, v132
  v_rcp_f32 v133, v133
  v_rcp_f32 v134, v134
  v_rcp_f32 v135, v135
  v_rcp_f32 v148, v148
  v_rcp_f32 v149, v149
  v_rcp_f32 v150, v150
  v_rcp_f32 v151, v151
  v_rcp_f32 v164, v164
  v_rcp_f32 v165, v165
  v_rcp_f32 v166, v166
  v_rcp_f32 v167, v167
  v_rcp_f32 v180, v180
  v_rcp_f32 v181, v181
  v_rcp_f32_e64 v182, v182
  v_rcp_f32 v183, v183
  v_pk_fma_f32 v[136:137], v[128:129], v[132:133], v[88:89]
  v_pk_fma_f32 v[138:139], v[130:131], v[134:135], v[90:91]
  s_mov_b32 s35, 0
  buffer_store_dwordx4 v[136:139], v47, s[4:7], s35 offen sc1
  v_pk_fma_f32 v[152:153], v[144:145], v[148:149], v[92:93]
  v_pk_fma_f32 v[154:155], v[146:147], v[150:151], v[94:95]
  s_mov_b32 s35, 8192
  buffer_store_dwordx4 v[152:155], v47, s[4:7], s35 offen sc1
  v_pk_fma_f32 v[168:169], v[160:161], v[164:165], v[96:97]
  v_pk_fma_f32 v[170:171], v[162:163], v[166:167], v[98:99]
  s_mov_b32 s35, 16384
  buffer_store_dwordx4 v[168:171], v47, s[4:7], s35 offen sc1
  v_pk_fma_f32 v[184:185], v[176:177], v[180:181], v[100:101]
  v_pk_fma_f32 v[186:187], v[178:179], v[182:183], v[102:103]
  s_mov_b32 s35, 24576
  buffer_store_dwordx4 v[184:187], v47, s[4:7], s35 offen sc1
  s_endpgm
K1_EPSPIN:
  s_mov_b32 s47, 0x100000
K1_EPSPIN_L:
  v_mov_b32 v78, 0
  buffer_load_dword v78, v78, s[24:27], 0 offen sc1
  s_waitcnt vmcnt(0)
  v_readfirstlane_b32 s50, v78
  s_nop 3
  s_cmp_lg_u32 s50, 0
  s_cbranch_scc1 K1_EPBACK
  s_sub_u32 s47, s47, 1
  s_cmp_lg_u32 s47, 0
  s_cbranch_scc1 K1_EPSPIN_L
  s_branch K1_EPBACK
K1_LBSPIN:
  s_add_u32 s49, s49, 1
  s_cmp_gt_u32 s49, 0x100000
  s_cbranch_scc1 K1_LBGIVE
  buffer_load_dwordx4 v[84:87], v71, s[20:23], 0 offen sc1
  buffer_load_dwordx4 v[88:91], v72, s[20:23], 0 offen sc1
  s_waitcnt vmcnt(0)
  s_branch K1_LBBACK
K1_LBGIVE:
  s_mov_b64 s[84:85], 0
  s_mov_b64 s[86:87], 0
  s_branch K1_LBBACK
F_HSPIN:
  s_add_u32 s49, s49, 1
  s_cmp_gt_u32 s49, 0x100000
  s_cbranch_scc1 F_HGIVE
  buffer_load_dword v32, v31, s[20:23], 0 offen offset:0 sc1
  s_waitcnt vmcnt(0)
  s_branch F_HBACK
F_HGIVE:
  v_mov_b32 v32, s50
  s_branch F_HBACK
F_ASPIN:
  s_add_u32 s49, s49, 1
  s_cmp_gt_u32 s49, 0x100000
  s_cbranch_scc1 F_AGIVE
  buffer_load_dword v32, v31, s[20:23], 0 offen offset:256 sc1
  s_waitcnt vmcnt(0)
  s_branch F_ABACK
F_AGIVE:
  v_mov_b32 v32, s50
  s_branch F_ABACK
F_BSPIN:
  s_add_u32 s49, s49, 1
  s_cmp_gt_u32 s49, 0x100000
  s_cbranch_scc1 F_BGIVE
  buffer_load_dword v32, v31, s[20:23], 0 offen offset:512 sc1
  s_waitcnt vmcnt(0)
  s_branch F_BBACK
F_BGIVE:
  v_mov_b32 v32, s50
  s_branch F_BBACK
K1_DONE:
  s_endpgm

.section .rodata,"a"
.p2align 6
.amdhsa_kernel recurrent_scan__ssm_conv_s5__swiglu_ffn__prompt_kernel
  .amdhsa_next_free_vgpr 512
  .amdhsa_next_free_sgpr 102
  .amdhsa_accum_offset 256
  .amdhsa_group_segment_fixed_size 0
  .amdhsa_kernarg_size 128
  .amdhsa_user_sgpr_count 2
  .amdhsa_user_sgpr_kernarg_segment_ptr 1
  .amdhsa_system_sgpr_workgroup_id_x 1
  .amdhsa_float_denorm_mode_32 3
.end_amdhsa_kernel
.text
```
